```python
import torch

def _softmax(x, axis=-1):
    return torch.softmax(x, dim=axis)
def _gelu(x):
    return torch.nn.functional.gelu(x, approximate="tanh")
def _silu(x):
    return torch.nn.functional.silu(x)
def _sigmoid(x):
    return torch.sigmoid(x)
def _layernorm(x, axis=-1, eps=1e-5):
    m = x.mean(dim=axis, keepdim=True)
    v = x.var(dim=axis, keepdim=True, unbiased=False)
    return (x - m) / torch.sqrt(v + eps)
def _scatter_add(tgt, idx, src, axis=0):
    return tgt.clone().index_add_(axis, idx, src)
def _segment_sum(src, seg, n):
    out = torch.zeros((n,) + src.shape[1:], dtype=src.dtype)
    return out.index_add_(0, seg, src)
def _pad(x, pw):
    flat = tuple(v for pair in reversed(pw) for v in pair)
    return torch.nn.functional.pad(x, flat)

kernel_name = 'sequential_preLN__linear_kernel_hedgehog__moe_arch_mod__prompt'

def setup_inputs():

    _w = (lambda a: (lambda t: t.to(torch.bfloat16) if t.is_floating_point() else t)(torch.as_tensor(a)))
    def _A_setup():
        B, S, D, H = 1, 2048, 576, 32
        Dh = D // H
        return {
            "x": _w((lambda *s: torch.randn(*s, dtype=torch.bfloat16) * 0.05)(B, S, D)),
            "wqkv": _w((lambda *s: torch.randn(*s, dtype=torch.bfloat16) * 0.2)(D, 3 * D)),
            "w_phi": _w((lambda *s: torch.randn(*s, dtype=torch.bfloat16) * 0.2)(H, Dh, Dh) * (Dh ** -0.5)),
            "wo": _w((lambda *s: torch.randn(*s, dtype=torch.bfloat16) * 0.05)(D, D)),
        }
    _A_in = _A_setup()

    def _B_setup():
        B, S, D, F, C = 1, 2048, 576, 4608, 8
        return {
            "x": _w((lambda *s: torch.randn(*s, dtype=torch.bfloat16) * 0.05)(B, S, D)),
            "w_r": _w((lambda *s: torch.randn(*s, dtype=torch.bfloat16) * 0.05)(D)),
            "w_gate": _w((lambda *s: torch.randn(*s, dtype=torch.bfloat16) * 0.05)(D, F)),
            "w_up": _w((lambda *s: torch.randn(*s, dtype=torch.bfloat16) * 0.05)(D, F)),
            "w_down": _w((lambda *s: torch.randn(*s, dtype=torch.bfloat16) * 0.05)(F, D)),
        }
    _B_in = _B_setup()

    return {
        "A_x": _A_in["x"],
        "A_wqkv": _A_in["wqkv"],
        "A_w_phi": _A_in["w_phi"],
        "A_wo": _A_in["wo"],
        "B_x": _B_in["x"],
        "B_w_r": _B_in["w_r"],
        "B_w_gate": _B_in["w_gate"],
        "B_w_up": _B_in["w_up"],
        "B_w_down": _B_in["w_down"],
    }

def reference(A_x, A_wqkv, A_w_phi, A_wo, B_x, B_w_r, B_w_gate, B_w_up, B_w_down):
    def _A_ref(x, wqkv, w_phi, wo):
        B, S, D = x.shape
        H = 32; Dh = D // H
        qkv = (lambda x, *d: x.permute(*d))((x @ wqkv).reshape(B, S, 3, H, Dh), 2, 0, 3, 1, 4)
        q, k, v = qkv[0], qkv[1], qkv[2]
        pq = torch.einsum("bhsd,hdf->bhsf", q, w_phi)
        pk = torch.einsum("bhsd,hdf->bhsf", k, w_phi)
        phi_q = torch.concatenate([_softmax(pq, axis=-1), _softmax(-pq, axis=-1)], axis=-1)
        phi_k = torch.concatenate([_softmax(pk, axis=-1), _softmax(-pk, axis=-1)], axis=-1)
        kv = torch.einsum("bhsf,bhsd->bhfd", phi_k, v)
        z  = torch.einsum("bhsf->bhf", phi_k)
        num = torch.einsum("bhqf,bhfd->bhqd", phi_q, kv)
        den = torch.einsum("bhqf,bhf->bhq", phi_q, z)[..., None] + 1e-6
        o = num / den
        return (lambda x, *d: x.permute(*d))(o, 0, 2, 1, 3).reshape(B, S, D) @ wo

    def _B_ref(x, w_r, w_gate, w_up, w_down):
        B, S, D = x.shape
        C = 8
        r = x @ w_r
        idx = torch.argsort(-r, axis=-1)[:, :C]
        idx_e = (lambda x, n, axis: torch.repeat_interleave(x, n, dim=axis))(idx.reshape(B, C, 1), D, axis=2)
        x_sel = (lambda x, i, axis: torch.take_along_dim(x, i, dim=axis))(x, idx_e, axis=1)
        g = _silu(x_sel @ w_gate)
        u = x_sel @ w_up
        y = (g * u) @ w_down
        r_sel = _sigmoid((lambda x, i, axis: torch.take_along_dim(x, i, dim=axis))(r, idx, axis=1))
        y = y * r_sel.reshape(B, C, 1)
        b_off = (torch.arange(B) * S).reshape(B, 1)
        flat_idx = (idx + b_off).reshape(B * C)
        zero = (x * 0.0).reshape(B * S, D)
        upd = _scatter_add(zero, flat_idx, y.reshape(B * C, D), axis=0)
        return x + upd.reshape(B, S, D)

    x = A_x
    h = x + _A_ref(_layernorm(x, axis=-1), A_wqkv, A_w_phi, A_wo)
    h2 = h + _B_ref(_layernorm(h, axis=-1), B_w_r, B_w_gate, B_w_up, B_w_down)
    return h2
```

```asm
; @launch grid=(256,1,1) block=(512,1,1) lds=163840
.amdgcn_target "amdgcn-amd-amdhsa--gfx950"
.text
.globl sequential_preLN__linear_kernel_hedgehog__moe_arch_mod__prompt_kernel
.p2align 8
.type sequential_preLN__linear_kernel_hedgehog__moe_arch_mod__prompt_kernel,@function
sequential_preLN__linear_kernel_hedgehog__moe_arch_mod__prompt_kernel:
    s_cmp_ge_u32 s2, 256
    s_cbranch_scc1 K1_END
    s_getpc_b64 s[46:47]
    v_lshlrev_b32 v5, 4, v0
    global_load_dwordx4 a[140:143], v5, s[46:47]
    s_load_dwordx2 s[6:7], s[0:1], 88
    s_load_dwordx2 s[4:5], s[0:1], 0
    s_load_dwordx4 s[32:35], s[0:1], 8
    s_load_dwordx2 s[36:37], s[0:1], 24
    s_load_dwordx2 s[38:39], s[0:1], 40
    s_load_dwordx4 s[8:11], s[0:1], 48
    s_load_dwordx4 s[12:15], s[0:1], 64
    s_lshr_b32 s48, s2, 3
    s_mul_hi_u32 s49, s48, 1073741825
    s_mul_i32 s49, s49, 4
    s_sub_u32 s48, s48, s49
    s_add_u32 s48, s48, 2
    s_lshl_b32 s48, s48, 12
    v_and_b32 v5, 0xfff, v5
    v_add_u32 v5, s48, v5
    global_load_dwordx4 a[136:139], v5, s[46:47]
    v_mov_b32 v4, v0
    v_lshrrev_b32 v1, 6, v0
    v_and_b32 v0, 63, v0
    v_readfirstlane_b32 s3, v1
    v_lshlrev_b32 v1, 4, v0
    s_and_b32 s44, s2, 7
    s_lshr_b32 s45, s2, 3
    s_lshr_b32 s40, s44, 1
    s_lshl_b32 s40, s40, 2
    s_lshr_b32 s46, s45, 3
    s_add_u32 s40, s40, s46
    s_and_b32 s41, s44, 1
    s_lshl_b32 s41, s41, 3
    s_and_b32 s46, s45, 7
    s_add_u32 s41, s41, s46
    s_lshl_b32 s42, s40, 2
    s_lshr_b32 s46, s41, 2
    s_add_u32 s42, s42, s46
    s_and_b32 s43, s41, 3
    s_and_b32 s55, s3, 3
    v_and_b32 v2, 15, v0
    v_lshrrev_b32 v3, 4, v0
    s_waitcnt lgkmcnt(0)
    s_mov_b32 s16, s6
    s_mov_b32 s17, s7
    s_mov_b32 s18, 27721728
    s_mov_b32 s19, 0x20000
    s_cmp_eq_u32 s3, 7
    s_cbranch_scc1 S0_E
    s_cmp_eq_u32 s3, 5
    s_cbranch_scc1 S0_M
    s_cmp_eq_u32 s3, 4
    s_cbranch_scc1 S0_M
    s_sub_u32 s46, s3, 1
    s_cmp_lt_u32 s46, 3
    s_cbranch_scc1 S0_W
S0_X:
    s_mov_b32 s20, s4
    s_mov_b32 s21, s5
    s_mov_b32 s22, 2359296
    s_mov_b32 s23, 0x20000
    s_lshl_b32 s46, s40, 7
    s_lshl_b32 s47, s41, 3
    s_add_u32 s46, s46, s47
    v_lshrrev_b32 v14, 3, v0
    v_add_u32 v14, s46, v14
    v_and_b32 v13, 7, v0
    v_mul_u32_u24 v15, 1152, v14
    v_lshl_add_u32 v15, v13, 4, v15
    buffer_load_dwordx4 v[16:19], v15, s[20:23], 0 offen offset:0
    buffer_load_dwordx4 v[20:23], v15, s[20:23], 0 offen offset:128
    buffer_load_dwordx4 v[24:27], v15, s[20:23], 0 offen offset:256
    buffer_load_dwordx4 v[28:31], v15, s[20:23], 0 offen offset:384
    buffer_load_dwordx4 v[32:35], v15, s[20:23], 0 offen offset:512
    buffer_load_dwordx4 v[36:39], v15, s[20:23], 0 offen offset:640
    buffer_load_dwordx4 v[40:43], v15, s[20:23], 0 offen offset:768
    buffer_load_dwordx4 v[44:47], v15, s[20:23], 0 offen offset:896
    buffer_load_dwordx4 v[48:51], v15, s[20:23], 0 offen offset:1024
    v_lshrrev_b32 v56, 4, v14
    v_mul_u32_u24 v56, 18432, v56
    v_and_b32 v14, 15, v14
    v_lshl_add_u32 v56, v14, 4, v56
    v_lshrrev_b32 v14, 2, v13
    v_lshl_add_u32 v56, v14, 10, v56
    v_and_b32 v14, 3, v13
    v_lshl_add_u32 v56, v14, 8, v56
    s_mov_b32 s46, 0x3f803f80
    v_mov_b32 v60, 0
    v_mov_b32 v61, 0
    v_mov_b32 v62, 0
    v_mov_b32 v63, 0
    v_mov_b32 v64, 0
    v_mov_b32 v65, 0
    v_mov_b32 v66, 0
    v_mov_b32 v67, 0
    s_waitcnt vmcnt(0)
    v_dot2c_f32_bf16 v60, s46, v16
    v_dot2c_f32_bf16 v64, v16, v16
    v_dot2c_f32_bf16 v61, s46, v17
    v_dot2c_f32_bf16 v65, v17, v17
    v_dot2c_f32_bf16 v62, s46, v18
    v_dot2c_f32_bf16 v66, v18, v18
    v_dot2c_f32_bf16 v63, s46, v19
    v_dot2c_f32_bf16 v67, v19, v19
    v_dot2c_f32_bf16 v60, s46, v20
    v_dot2c_f32_bf16 v64, v20, v20
    v_dot2c_f32_bf16 v61, s46, v21
    v_dot2c_f32_bf16 v65, v21, v21
    v_dot2c_f32_bf16 v62, s46, v22
    v_dot2c_f32_bf16 v66, v22, v22
    v_dot2c_f32_bf16 v63, s46, v23
    v_dot2c_f32_bf16 v67, v23, v23
    v_dot2c_f32_bf16 v60, s46, v24
    v_dot2c_f32_bf16 v64, v24, v24
    v_dot2c_f32_bf16 v61, s46, v25
    v_dot2c_f32_bf16 v65, v25, v25
    v_dot2c_f32_bf16 v62, s46, v26
    v_dot2c_f32_bf16 v66, v26, v26
    v_dot2c_f32_bf16 v63, s46, v27
    v_dot2c_f32_bf16 v67, v27, v27
    v_dot2c_f32_bf16 v60, s46, v28
    v_dot2c_f32_bf16 v64, v28, v28
    v_dot2c_f32_bf16 v61, s46, v29
    v_dot2c_f32_bf16 v65, v29, v29
    v_dot2c_f32_bf16 v62, s46, v30
    v_dot2c_f32_bf16 v66, v30, v30
    v_dot2c_f32_bf16 v63, s46, v31
    v_dot2c_f32_bf16 v67, v31, v31
    v_dot2c_f32_bf16 v60, s46, v32
    v_dot2c_f32_bf16 v64, v32, v32
    v_dot2c_f32_bf16 v61, s46, v33
    v_dot2c_f32_bf16 v65, v33, v33
    v_dot2c_f32_bf16 v62, s46, v34
    v_dot2c_f32_bf16 v66, v34, v34
    v_dot2c_f32_bf16 v63, s46, v35
    v_dot2c_f32_bf16 v67, v35, v35
    v_dot2c_f32_bf16 v60, s46, v36
    v_dot2c_f32_bf16 v64, v36, v36
    v_dot2c_f32_bf16 v61, s46, v37
    v_dot2c_f32_bf16 v65, v37, v37
    v_dot2c_f32_bf16 v62, s46, v38
    v_dot2c_f32_bf16 v66, v38, v38
    v_dot2c_f32_bf16 v63, s46, v39
    v_dot2c_f32_bf16 v67, v39, v39
    v_dot2c_f32_bf16 v60, s46, v40
    v_dot2c_f32_bf16 v64, v40, v40
    v_dot2c_f32_bf16 v61, s46, v41
    v_dot2c_f32_bf16 v65, v41, v41
    v_dot2c_f32_bf16 v62, s46, v42
    v_dot2c_f32_bf16 v66, v42, v42
    v_dot2c_f32_bf16 v63, s46, v43
    v_dot2c_f32_bf16 v67, v43, v43
    v_dot2c_f32_bf16 v60, s46, v44
    v_dot2c_f32_bf16 v64, v44, v44
    v_dot2c_f32_bf16 v61, s46, v45
    v_dot2c_f32_bf16 v65, v45, v45
    v_dot2c_f32_bf16 v62, s46, v46
    v_dot2c_f32_bf16 v66, v46, v46
    v_dot2c_f32_bf16 v63, s46, v47
    v_dot2c_f32_bf16 v67, v47, v47
    v_dot2c_f32_bf16 v60, s46, v48
    v_dot2c_f32_bf16 v64, v48, v48
    v_dot2c_f32_bf16 v61, s46, v49
    v_dot2c_f32_bf16 v65, v49, v49
    v_dot2c_f32_bf16 v62, s46, v50
    v_dot2c_f32_bf16 v66, v50, v50
    v_dot2c_f32_bf16 v63, s46, v51
    v_dot2c_f32_bf16 v67, v51, v51
    v_add_f32 v60, v60, v61
    s_nop 0
    v_add_f32 v62, v62, v63
    v_add_f32 v64, v64, v65
    v_add_f32 v66, v66, v67
    v_add_f32 v60, v60, v62
    v_add_f32 v64, v64, v66
    s_nop 0
    v_add_f32_dpp v60, v60, v60 quad_perm:[1,0,3,2] row_mask:0xf bank_mask:0xf
    v_add_f32_dpp v64, v64, v64 quad_perm:[1,0,3,2] row_mask:0xf bank_mask:0xf
    s_nop 0
    v_add_f32_dpp v60, v60, v60 quad_perm:[2,3,0,1] row_mask:0xf bank_mask:0xf
    v_add_f32_dpp v64, v64, v64 quad_perm:[2,3,0,1] row_mask:0xf bank_mask:0xf
    s_nop 0
    v_add_f32_dpp v60, v60, v60 row_half_mirror row_mask:0xf bank_mask:0xf
    v_add_f32_dpp v64, v64, v64 row_half_mirror row_mask:0xf bank_mask:0xf
    s_mov_b32 s46, 0x3AE38E39
    v_mul_f32 v60, s46, v60
    v_mul_f32 v64, s46, v64
    v_fma_f32 v64, -v60, v60, v64
    v_add_f32 v64, 0x3727c5ac, v64
    v_rsq_f32 v64, v64
    s_nop 0
    v_mul_f32 v60, v60, v64
    v_sub_f32 v60, 0, v60
    v_mov_b32 v65, v64
    v_mov_b32 v61, v60
    s_cmp_eq_u32 s3, 6
    s_cbranch_scc1 S0_X6_1
    v_lshlrev_b32 v68, 16, v16
    v_and_b32 v69, 0xffff0000, v16
    v_pk_fma_f32 v[68:69], v[68:69], v[64:65], v[60:61]
    v_cvt_pk_bf16_f32 v16, v68, v69
    v_lshlrev_b32 v68, 16, v17
    v_and_b32 v69, 0xffff0000, v17
    v_pk_fma_f32 v[68:69], v[68:69], v[64:65], v[60:61]
    v_cvt_pk_bf16_f32 v17, v68, v69
    v_lshlrev_b32 v68, 16, v18
    v_and_b32 v69, 0xffff0000, v18
    v_pk_fma_f32 v[68:69], v[68:69], v[64:65], v[60:61]
    v_cvt_pk_bf16_f32 v18, v68, v69
    v_lshlrev_b32 v68, 16, v19
    v_and_b32 v69, 0xffff0000, v19
    v_pk_fma_f32 v[68:69], v[68:69], v[64:65], v[60:61]
    v_cvt_pk_bf16_f32 v19, v68, v69
    s_mov_b32 s46, 0
    buffer_store_dwordx4 v[16:19], v56, s[16:19], s46 offen sc1
    v_lshlrev_b32 v68, 16, v20
    v_and_b32 v69, 0xffff0000, v20
    v_pk_fma_f32 v[68:69], v[68:69], v[64:65], v[60:61]
    v_cvt_pk_bf16_f32 v20, v68, v69
    v_lshlrev_b32 v68, 16, v21
    v_and_b32 v69, 0xffff0000, v21
    v_pk_fma_f32 v[68:69], v[68:69], v[64:65], v[60:61]
    v_cvt_pk_bf16_f32 v21, v68, v69
    v_lshlrev_b32 v68, 16, v22
    v_and_b32 v69, 0xffff0000, v22
    v_pk_fma_f32 v[68:69], v[68:69], v[64:65], v[60:61]
    v_cvt_pk_bf16_f32 v22, v68, v69
    v_lshlrev_b32 v68, 16, v23
    v_and_b32 v69, 0xffff0000, v23
    v_pk_fma_f32 v[68:69], v[68:69], v[64:65], v[60:61]
    v_cvt_pk_bf16_f32 v23, v68, v69
    s_mov_b32 s46, 2048
    buffer_store_dwordx4 v[20:23], v56, s[16:19], s46 offen sc1
    v_lshlrev_b32 v68, 16, v24
    v_and_b32 v69, 0xffff0000, v24
    v_pk_fma_f32 v[68:69], v[68:69], v[64:65], v[60:61]
    v_cvt_pk_bf16_f32 v24, v68, v69
    v_lshlrev_b32 v68, 16, v25
    v_and_b32 v69, 0xffff0000, v25
    v_pk_fma_f32 v[68:69], v[68:69], v[64:65], v[60:61]
    v_cvt_pk_bf16_f32 v25, v68, v69
    v_lshlrev_b32 v68, 16, v26
    v_and_b32 v69, 0xffff0000, v26
    v_pk_fma_f32 v[68:69], v[68:69], v[64:65], v[60:61]
    v_cvt_pk_bf16_f32 v26, v68, v69
    v_lshlrev_b32 v68, 16, v27
    v_and_b32 v69, 0xffff0000, v27
    v_pk_fma_f32 v[68:69], v[68:69], v[64:65], v[60:61]
    v_cvt_pk_bf16_f32 v27, v68, v69
    s_mov_b32 s46, 4096
    buffer_store_dwordx4 v[24:27], v56, s[16:19], s46 offen sc1
    v_lshlrev_b32 v68, 16, v28
    v_and_b32 v69, 0xffff0000, v28
    v_pk_fma_f32 v[68:69], v[68:69], v[64:65], v[60:61]
    v_cvt_pk_bf16_f32 v28, v68, v69
    v_lshlrev_b32 v68, 16, v29
    v_and_b32 v69, 0xffff0000, v29
    v_pk_fma_f32 v[68:69], v[68:69], v[64:65], v[60:61]
    v_cvt_pk_bf16_f32 v29, v68, v69
    v_lshlrev_b32 v68, 16, v30
    v_and_b32 v69, 0xffff0000, v30
    v_pk_fma_f32 v[68:69], v[68:69], v[64:65], v[60:61]
    v_cvt_pk_bf16_f32 v30, v68, v69
    v_lshlrev_b32 v68, 16, v31
    v_and_b32 v69, 0xffff0000, v31
    v_pk_fma_f32 v[68:69], v[68:69], v[64:65], v[60:61]
    v_cvt_pk_bf16_f32 v31, v68, v69
    s_mov_b32 s46, 6144
    buffer_store_dwordx4 v[28:31], v56, s[16:19], s46 offen sc1
    v_lshlrev_b32 v68, 16, v32
    v_and_b32 v69, 0xffff0000, v32
    v_pk_fma_f32 v[68:69], v[68:69], v[64:65], v[60:61]
    v_cvt_pk_bf16_f32 v32, v68, v69
    v_lshlrev_b32 v68, 16, v33
    v_and_b32 v69, 0xffff0000, v33
    v_pk_fma_f32 v[68:69], v[68:69], v[64:65], v[60:61]
    v_cvt_pk_bf16_f32 v33, v68, v69
    v_lshlrev_b32 v68, 16, v34
    v_and_b32 v69, 0xffff0000, v34
    v_pk_fma_f32 v[68:69], v[68:69], v[64:65], v[60:61]
    v_cvt_pk_bf16_f32 v34, v68, v69
    v_lshlrev_b32 v68, 16, v35
    v_and_b32 v69, 0xffff0000, v35
    v_pk_fma_f32 v[68:69], v[68:69], v[64:65], v[60:61]
    v_cvt_pk_bf16_f32 v35, v68, v69
    s_mov_b32 s46, 8192
    buffer_store_dwordx4 v[32:35], v56, s[16:19], s46 offen sc1
    s_branch S0_JOIN
S0_X6_1:
    v_lshlrev_b32 v68, 16, v36
    v_and_b32 v69, 0xffff0000, v36
    v_pk_fma_f32 v[68:69], v[68:69], v[64:65], v[60:61]
    v_cvt_pk_bf16_f32 v36, v68, v69
    v_lshlrev_b32 v68, 16, v37
    v_and_b32 v69, 0xffff0000, v37
    v_pk_fma_f32 v[68:69], v[68:69], v[64:65], v[60:61]
    v_cvt_pk_bf16_f32 v37, v68, v69
    v_lshlrev_b32 v68, 16, v38
    v_and_b32 v69, 0xffff0000, v38
    v_pk_fma_f32 v[68:69], v[68:69], v[64:65], v[60:61]
    v_cvt_pk_bf16_f32 v38, v68, v69
    v_lshlrev_b32 v68, 16, v39
    v_and_b32 v69, 0xffff0000, v39
    v_pk_fma_f32 v[68:69], v[68:69], v[64:65], v[60:61]
    v_cvt_pk_bf16_f32 v39, v68, v69
    s_mov_b32 s46, 10240
    buffer_store_dwordx4 v[36:39], v56, s[16:19], s46 offen sc1
    v_lshlrev_b32 v68, 16, v40
    v_and_b32 v69, 0xffff0000, v40
    v_pk_fma_f32 v[68:69], v[68:69], v[64:65], v[60:61]
    v_cvt_pk_bf16_f32 v40, v68, v69
    v_lshlrev_b32 v68, 16, v41
    v_and_b32 v69, 0xffff0000, v41
    v_pk_fma_f32 v[68:69], v[68:69], v[64:65], v[60:61]
    v_cvt_pk_bf16_f32 v41, v68, v69
    v_lshlrev_b32 v68, 16, v42
    v_and_b32 v69, 0xffff0000, v42
    v_pk_fma_f32 v[68:69], v[68:69], v[64:65], v[60:61]
    v_cvt_pk_bf16_f32 v42, v68, v69
    v_lshlrev_b32 v68, 16, v43
    v_and_b32 v69, 0xffff0000, v43
    v_pk_fma_f32 v[68:69], v[68:69], v[64:65], v[60:61]
    v_cvt_pk_bf16_f32 v43, v68, v69
    s_mov_b32 s46, 12288
    buffer_store_dwordx4 v[40:43], v56, s[16:19], s46 offen sc1
    v_lshlrev_b32 v68, 16, v44
    v_and_b32 v69, 0xffff0000, v44
    v_pk_fma_f32 v[68:69], v[68:69], v[64:65], v[60:61]
    v_cvt_pk_bf16_f32 v44, v68, v69
    v_lshlrev_b32 v68, 16, v45
    v_and_b32 v69, 0xffff0000, v45
    v_pk_fma_f32 v[68:69], v[68:69], v[64:65], v[60:61]
    v_cvt_pk_bf16_f32 v45, v68, v69
    v_lshlrev_b32 v68, 16, v46
    v_and_b32 v69, 0xffff0000, v46
    v_pk_fma_f32 v[68:69], v[68:69], v[64:65], v[60:61]
    v_cvt_pk_bf16_f32 v46, v68, v69
    v_lshlrev_b32 v68, 16, v47
    v_and_b32 v69, 0xffff0000, v47
    v_pk_fma_f32 v[68:69], v[68:69], v[64:65], v[60:61]
    v_cvt_pk_bf16_f32 v47, v68, v69
    s_mov_b32 s46, 14336
    buffer_store_dwordx4 v[44:47], v56, s[16:19], s46 offen sc1
    v_lshlrev_b32 v68, 16, v48
    v_and_b32 v69, 0xffff0000, v48
    v_pk_fma_f32 v[68:69], v[68:69], v[64:65], v[60:61]
    v_cvt_pk_bf16_f32 v48, v68, v69
    v_lshlrev_b32 v68, 16, v49
    v_and_b32 v69, 0xffff0000, v49
    v_pk_fma_f32 v[68:69], v[68:69], v[64:65], v[60:61]
    v_cvt_pk_bf16_f32 v49, v68, v69
    v_lshlrev_b32 v68, 16, v50
    v_and_b32 v69, 0xffff0000, v50
    v_pk_fma_f32 v[68:69], v[68:69], v[64:65], v[60:61]
    v_cvt_pk_bf16_f32 v50, v68, v69
    v_lshlrev_b32 v68, 16, v51
    v_and_b32 v69, 0xffff0000, v51
    v_pk_fma_f32 v[68:69], v[68:69], v[64:65], v[60:61]
    v_cvt_pk_bf16_f32 v51, v68, v69
    s_mov_b32 s46, 16384
    buffer_store_dwordx4 v[48:51], v56, s[16:19], s46 offen sc1
    s_branch S0_JOIN
S0_W:
    s_sub_u32 s48, s3, 1
    s_lshl_b32 s48, s48, 4
    s_add_u32 s48, s48, s40
    s_cmp_ge_u32 s48, 36
    s_cbranch_scc1 S0_O
    s_mov_b32 s24, s34
    s_mov_b32 s25, s35
    s_mov_b32 s26, 20736
    s_mov_b32 s27, 0x20000
    s_mov_b32 s20, s32
    s_mov_b32 s21, s33
    s_mov_b32 s22, 1990656
    s_mov_b32 s23, 0x20000
    v_lshrrev_b32 v14, 2, v2
    v_lshlrev_b32 v14, 3, v14
    v_and_b32 v15, 3, v2
    v_add_u32 v14, v14, v15
    v_mov_b32 v13, 1073741824
    v_cmp_gt_u32 vcc, 18, v14
    v_add_u32 v12, 4, v14
    v_cmp_gt_u32 s[50:51], 18, v12
    v_mul_u32_u24 v14, 36, v14
    v_lshl_add_u32 v14, v3, 4, v14
    s_mul_i32 s46, s41, 1296
    v_add_u32 v14, s46, v14
    v_add_u32 v15, 144, v14
    v_cndmask_b32 v14, v13, v14, vcc
    v_cndmask_b32 v15, v13, v15, s[50:51]
    buffer_load_dwordx4 v[16:19], v14, s[24:27], 0 offen offset:0
    buffer_load_dwordx4 v[20:23], v15, s[24:27], 0 offen offset:0
    buffer_load_dwordx4 v[24:27], v14, s[24:27], 0 offen offset:648
    buffer_load_dwordx4 v[28:31], v15, s[24:27], 0 offen offset:648
    s_lshl_b32 s46, s48, 4
    v_add_u32 v14, s46, v2
    v_mul_u32_u24 v14, 3456, v14
    s_mul_i32 s46, s41, 72
    v_add_u32 v14, s46, v14
    v_lshl_add_u32 v14, v3, 4, v14
    buffer_load_dwordx4 v[40:43], v14, s[20:23], 0 offen offset:1152
    buffer_load_dwordx4 v[44:47], v14, s[20:23], 0 offen offset:1188
    buffer_load_dwordx4 v[48:51], v14, s[20:23], 0 offen offset:2304
    buffer_load_dwordx4 v[52:55], v14, s[20:23], 0 offen offset:2340
    buffer_load_dwordx4 v[32:35], v14, s[20:23], 0 offen offset:0
    buffer_load_dwordx4 v[36:39], v14, s[20:23], 0 offen offset:36
    v_lshlrev_b32 v97, 3, v3
    v_sub_u32 v97, v2, v97
    v_mov_b32 v98, 100
    v_cmp_gt_u32 vcc, 9, v2
    s_nop 1
    v_cndmask_b32 v97, v98, v97, vcc
    v_mov_b32 v98, 0x3f80
    v_mov_b32 v99, 0x3f800000
    v_mov_b32 v100, 0
    v_cmp_eq_u32 vcc, 0, v97
    s_nop 1
    v_cndmask_b32 v56, v100, v98, vcc
    v_cmp_eq_u32 vcc, 1, v97
    s_nop 1
    v_cndmask_b32 v56, v56, v99, vcc
    v_cmp_eq_u32 vcc, 2, v97
    s_nop 1
    v_cndmask_b32 v57, v100, v98, vcc
    v_cmp_eq_u32 vcc, 3, v97
    s_nop 1
    v_cndmask_b32 v57, v57, v99, vcc
    v_cmp_eq_u32 vcc, 4, v97
    s_nop 1
    v_cndmask_b32 v58, v100, v98, vcc
    v_cmp_eq_u32 vcc, 5, v97
    s_nop 1
    v_cndmask_b32 v58, v58, v99, vcc
    v_cmp_eq_u32 vcc, 6, v97
    s_nop 1
    v_cndmask_b32 v59, v100, v98, vcc
    v_cmp_eq_u32 vcc, 7, v97
    s_nop 1
    v_cndmask_b32 v59, v59, v99, vcc
    v_add_u32 v97, 9, v97
    v_cmp_eq_u32 vcc, 0, v97
    s_nop 1
    v_cndmask_b32 v60, v100, v98, vcc
    v_cmp_eq_u32 vcc, 1, v97
    s_nop 1
    v_cndmask_b32 v60, v60, v99, vcc
    v_cmp_eq_u32 vcc, 2, v97
    s_nop 1
    v_cndmask_b32 v61, v100, v98, vcc
    v_cmp_eq_u32 vcc, 3, v97
    s_nop 1
    v_cndmask_b32 v61, v61, v99, vcc
    v_cmp_eq_u32 vcc, 4, v97
    s_nop 1
    v_cndmask_b32 v62, v100, v98, vcc
    v_cmp_eq_u32 vcc, 5, v97
    s_nop 1
    v_cndmask_b32 v62, v62, v99, vcc
    v_cmp_eq_u32 vcc, 6, v97
    s_nop 1
    v_cndmask_b32 v63, v100, v98, vcc
    v_cmp_eq_u32 vcc, 7, v97
    s_nop 1
    v_cndmask_b32 v63, v63, v99, vcc
    s_sub_u32 s46, s3, 1
    s_lshl_b32 s52, s46, 12
    v_lshrrev_b32 v104, 1, v3
    v_lshlrev_b32 v104, 8, v104
    v_and_b32 v105, 1, v3
    v_lshl_add_u32 v104, v105, 3, v104
    v_add_u32 v104, s52, v104
    s_add_u32 s53, s52, 3584
    v_mov_b32 v109, s53
    v_add_u32 v105, 0, v2
    v_lshrrev_b32 v106, 2, v105
    v_and_b32 v105, 3, v105
    v_lshlrev_b32 v105, 4, v105
    v_lshl_add_u32 v105, v106, 9, v105
    v_add_u32 v105, v105, v104
    v_cmp_gt_u32 vcc, 9, v2
    s_nop 1
    v_cndmask_b32 v101, v109, v105, vcc
    v_add_u32 v105, 9, v2
    v_lshrrev_b32 v106, 2, v105
    v_and_b32 v105, 3, v105
    v_lshlrev_b32 v105, 4, v105
    v_lshl_add_u32 v105, v106, 9, v105
    v_add_u32 v105, v105, v104
    v_cmp_gt_u32 vcc, 9, v2
    s_nop 1
    v_cndmask_b32 v102, v109, v105, vcc
    v_add_u32 v105, 18, v2
    v_lshrrev_b32 v106, 2, v105
    v_and_b32 v105, 3, v105
    v_lshlrev_b32 v105, 4, v105
    v_lshl_add_u32 v105, v106, 9, v105
    v_add_u32 v105, v105, v104
    v_cmp_gt_u32 vcc, 9, v2
    s_nop 1
    v_cndmask_b32 v103, v109, v105, vcc
    s_lshr_b32 s46, s48, 1
    s_mul_i32 s47, s46, 5120
    s_lshl_b32 s49, s46, 11
    s_add_u32 s49, s49, 87040
    s_mul_i32 s50, s41, 129024
    s_add_u32 s50, s50, 2359296
    s_and_b32 s51, s48, 1
    s_lshl_b32 s51, s51, 9
    s_add_u32 s50, s50, s51
    v_and_b32 v105, 31, v0
    v_lshlrev_b32 v105, 4, v105
    v_add_u32 v105, s50, v105
    v_lshrrev_b32 v106, 5, v0
    v_add_u32 v107, 0, v106
    v_mov_b32 v108, s47
    v_mov_b32 v100, s49
    v_cmp_gt_u32 vcc, 5, v107
    s_nop 1
    v_cndmask_b32 v108, v100, v108, vcc
    v_lshl_add_u32 v108, v107, 10, v108
    v_add_u32 v108, v108, v105
    v_cmp_gt_u32 vcc, 7, v107
    s_nop 1
    v_cndmask_b32 v8, v13, v108, vcc
    v_add_u32 v107, 2, v106
    v_mov_b32 v108, s47
    v_mov_b32 v100, s49
    v_cmp_gt_u32 vcc, 5, v107
    s_nop 1
    v_cndmask_b32 v108, v100, v108, vcc
    v_lshl_add_u32 v108, v107, 10, v108
    v_add_u32 v108, v108, v105
    v_cmp_gt_u32 vcc, 7, v107
    s_nop 1
    v_cndmask_b32 v9, v13, v108, vcc
    v_add_u32 v107, 4, v106
    v_mov_b32 v108, s47
    v_mov_b32 v100, s49
    v_cmp_gt_u32 vcc, 5, v107
    s_nop 1
    v_cndmask_b32 v108, v100, v108, vcc
    v_lshl_add_u32 v108, v107, 10, v108
    v_add_u32 v108, v108, v105
    v_cmp_gt_u32 vcc, 7, v107
    s_nop 1
    v_cndmask_b32 v10, v13, v108, vcc
    v_add_u32 v107, 6, v106
    v_mov_b32 v108, s47
    v_mov_b32 v100, s49
    v_cmp_gt_u32 vcc, 5, v107
    s_nop 1
    v_cndmask_b32 v108, v100, v108, vcc
    v_lshl_add_u32 v108, v107, 10, v108
    v_add_u32 v108, v108, v105
    v_cmp_gt_u32 vcc, 7, v107
    s_nop 1
    v_cndmask_b32 v11, v13, v108, vcc
    v_add_u32 v12, s52, v1
    v_mov_b32 v100, 0
    s_mov_b32 s46, 0x3fb8aa3b
    v_mov_b32 v110, s46
    s_waitcnt vmcnt(6)
    v_mfma_f32_16x16x32_bf16 v[80:83], v[16:19], v[56:59], 0
    v_mfma_f32_16x16x32_bf16 v[84:87], v[20:23], v[56:59], 0
    v_mfma_f32_16x16x32_bf16 v[88:91], v[16:19], v[60:63], 0
    v_mfma_f32_16x16x32_bf16 v[92:95], v[20:23], v[60:63], 0
    s_nop 4
    v_cvt_pk_bf16_f32 v64, v80, v81
    v_cvt_pk_bf16_f32 v65, v82, v83
    v_cvt_pk_bf16_f32 v66, v84, v85
    v_cvt_pk_bf16_f32 v67, v86, v87
    v_cvt_pk_bf16_f32 v68, v88, v89
    v_cvt_pk_bf16_f32 v69, v90, v91
    v_cvt_pk_bf16_f32 v70, v92, v93
    v_cvt_pk_bf16_f32 v71, v94, v95
    v_mfma_f32_16x16x32_bf16 v[80:83], v[24:27], v[56:59], 0
    v_mfma_f32_16x16x32_bf16 v[84:87], v[28:31], v[56:59], 0
    v_mfma_f32_16x16x32_bf16 v[88:91], v[24:27], v[60:63], 0
    v_mfma_f32_16x16x32_bf16 v[92:95], v[28:31], v[60:63], 0
    s_nop 4
    v_cvt_pk_bf16_f32 v72, v80, v81
    v_cvt_pk_bf16_f32 v73, v82, v83
    v_cvt_pk_bf16_f32 v74, v84, v85
    v_cvt_pk_bf16_f32 v75, v86, v87
    v_cvt_pk_bf16_f32 v76, v88, v89
    v_cvt_pk_bf16_f32 v77, v90, v91
    v_cvt_pk_bf16_f32 v78, v92, v93
    v_cvt_pk_bf16_f32 v79, v94, v95
    s_waitcnt vmcnt(0)
    v_mfma_f32_16x16x32_bf16 v[80:83], v[40:43], v[64:67], 0
    v_mfma_f32_16x16x32_bf16 v[84:87], v[40:43], v[68:71], 0
    v_mfma_f32_16x16x32_bf16 v[88:91], v[44:47], v[72:75], 0
    v_mfma_f32_16x16x32_bf16 v[92:95], v[44:47], v[76:79], 0
    s_nop 4
    v_pk_mul_f32 v[80:81], v[80:81], v[110:111] op_sel_hi:[1,0]
    v_pk_mul_f32 v[82:83], v[82:83], v[110:111] op_sel_hi:[1,0]
    v_cvt_pk_bf16_f32 v80, v80, v81
    v_cvt_pk_bf16_f32 v81, v82, v83
    ds_write_b64 v101, v[80:81] offset:0
    v_pk_mul_f32 v[84:85], v[84:85], v[110:111] op_sel_hi:[1,0]
    v_pk_mul_f32 v[86:87], v[86:87], v[110:111] op_sel_hi:[1,0]
    v_cvt_pk_bf16_f32 v84, v84, v85
    v_cvt_pk_bf16_f32 v85, v86, v87
    ds_write_b64 v101, v[84:85] offset:64
    v_pk_mul_f32 v[88:89], v[88:89], v[110:111] op_sel_hi:[1,0]
    v_pk_mul_f32 v[90:91], v[90:91], v[110:111] op_sel_hi:[1,0]
    v_cvt_pk_bf16_f32 v88, v88, v89
    v_cvt_pk_bf16_f32 v89, v90, v91
    ds_write_b64 v101, v[88:89] offset:128
    v_pk_mul_f32 v[92:93], v[92:93], v[110:111] op_sel_hi:[1,0]
    v_pk_mul_f32 v[94:95], v[94:95], v[110:111] op_sel_hi:[1,0]
    v_cvt_pk_bf16_f32 v92, v92, v93
    v_cvt_pk_bf16_f32 v93, v94, v95
    ds_write_b64 v101, v[92:93] offset:192
    s_waitcnt lgkmcnt(0)
    v_mfma_f32_16x16x32_bf16 v[16:19], v[48:51], v[56:59], 0
    v_mfma_f32_16x16x32_bf16 v[20:23], v[48:51], v[60:63], 0
    v_mfma_f32_16x16x32_bf16 v[24:27], v[52:55], v[56:59], 0
    v_mfma_f32_16x16x32_bf16 v[28:31], v[52:55], v[60:63], 0
    s_nop 4
    v_cvt_pk_bf16_f32 v16, v16, v17
    v_cvt_pk_bf16_f32 v17, v18, v19
    ds_write_b64 v102, v[16:17] offset:0
    v_cvt_pk_bf16_f32 v20, v20, v21
    v_cvt_pk_bf16_f32 v21, v22, v23
    ds_write_b64 v102, v[20:21] offset:64
    v_cvt_pk_bf16_f32 v24, v24, v25
    v_cvt_pk_bf16_f32 v25, v26, v27
    ds_write_b64 v102, v[24:25] offset:128
    v_cvt_pk_bf16_f32 v28, v28, v29
    v_cvt_pk_bf16_f32 v29, v30, v31
    ds_write_b64 v102, v[28:29] offset:192
    s_waitcnt lgkmcnt(0)
    v_mfma_f32_16x16x32_bf16 v[80:83], v[32:35], v[64:67], 0
    v_mfma_f32_16x16x32_bf16 v[84:87], v[32:35], v[68:71], 0
    v_mfma_f32_16x16x32_bf16 v[88:91], v[36:39], v[72:75], 0
    v_mfma_f32_16x16x32_bf16 v[92:95], v[36:39], v[76:79], 0
    s_nop 4
    v_pk_mul_f32 v[80:81], v[80:81], v[110:111] op_sel_hi:[1,0]
    v_pk_mul_f32 v[82:83], v[82:83], v[110:111] op_sel_hi:[1,0]
    v_cvt_pk_bf16_f32 v80, v80, v81
    v_cvt_pk_bf16_f32 v81, v82, v83
    ds_write_b64 v103, v[80:81] offset:0
    v_pk_mul_f32 v[84:85], v[84:85], v[110:111] op_sel_hi:[1,0]
    v_pk_mul_f32 v[86:87], v[86:87], v[110:111] op_sel_hi:[1,0]
    v_cvt_pk_bf16_f32 v84, v84, v85
    v_cvt_pk_bf16_f32 v85, v86, v87
    ds_write_b64 v103, v[84:85] offset:64
    v_pk_mul_f32 v[88:89], v[88:89], v[110:111] op_sel_hi:[1,0]
    v_pk_mul_f32 v[90:91], v[90:91], v[110:111] op_sel_hi:[1,0]
    v_cvt_pk_bf16_f32 v88, v88, v89
    v_cvt_pk_bf16_f32 v89, v90, v91
    ds_write_b64 v103, v[88:89] offset:128
    v_pk_mul_f32 v[92:93], v[92:93], v[110:111] op_sel_hi:[1,0]
    v_pk_mul_f32 v[94:95], v[94:95], v[110:111] op_sel_hi:[1,0]
    v_cvt_pk_bf16_f32 v92, v92, v93
    v_cvt_pk_bf16_f32 v93, v94, v95
    ds_write_b64 v103, v[92:93] offset:192
    s_waitcnt lgkmcnt(0)
    ds_read_b128 v[16:19], v12 offset:0
    ds_read_b128 v[20:23], v12 offset:1024
    ds_read_b128 v[24:27], v12 offset:2048
    ds_read_b128 v[28:31], v12 offset:3072
    s_waitcnt lgkmcnt(3)
    buffer_store_dwordx4 v[16:19], v8, s[16:19], 0 offen sc1
    s_waitcnt lgkmcnt(2)
    buffer_store_dwordx4 v[20:23], v9, s[16:19], 0 offen sc1
    s_waitcnt lgkmcnt(1)
    buffer_store_dwordx4 v[24:27], v10, s[16:19], 0 offen sc1
    s_waitcnt lgkmcnt(0)
    buffer_store_dwordx4 v[28:31], v11, s[16:19], 0 offen sc1
    s_branch S0_JOIN
S0_O:
    s_cmp_ge_u32 s45, 12
    s_cbranch_scc1 S0_M
    s_mov_b32 s20, s36
    s_mov_b32 s21, s37
    s_mov_b32 s22, 663552
    s_mov_b32 s23, 0x20000
    s_sub_u32 s46, s44, 2
    s_mul_i32 s46, s46, 12
    s_add_u32 s46, s46, s45
    s_and_b32 s48, s46, 3
    s_lshr_b32 s49, s46, 2
    v_lshrrev_b32 v14, 3, v2
    s_lshl_b32 s46, s48, 3
    v_add_u32 v14, s46, v14
    v_mul_u32_u24 v14, 18, v14
    v_bfe_u32 v15, v2, 2, 1
    v_mad_u32_u24 v14, v15, 9, v14
    v_and_b32 v15, 3, v2
    v_mad_u32_u24 v12, v15, 36, v14
    v_add_u32 v12, 8, v12
    v_add_u32 v14, v14, v15
    v_mul_u32_u24 v14, 1152, v14
    v_mul_u32_u24 v12, 1152, v12
    s_lshl_b32 s46, s49, 6
    v_lshl_add_u32 v15, v3, 4, s46
    v_add_u32 v14, v14, v15
    v_add_u32 v12, v12, v15
    s_mov_b32 s50, 0
    buffer_load_dwordx4 v[16:19], v14, s[20:23], s50 offen
    s_mov_b32 s51, 4608
    buffer_load_dwordx4 v[20:23], v14, s[20:23], s51 offen
    s_mov_b32 s50, 41472
    buffer_load_dwordx4 v[24:27], v14, s[20:23], s50 offen
    s_mov_b32 s51, 46080
    buffer_load_dwordx4 v[28:31], v14, s[20:23], s51 offen
    s_mov_b32 s50, 82944
    buffer_load_dwordx4 v[32:35], v14, s[20:23], s50 offen
    s_mov_b32 s51, 87552
    buffer_load_dwordx4 v[36:39], v14, s[20:23], s51 offen
    s_mov_b32 s50, 124416
    buffer_load_dwordx4 v[40:43], v14, s[20:23], s50 offen
    s_mov_b32 s51, 129024
    buffer_load_dwordx4 v[44:47], v14, s[20:23], s51 offen
    buffer_load_dwordx4 v[48:51], v12, s[20:23], 0 offen
    v_lshlrev_b32 v97, 3, v3
    v_sub_u32 v97, v2, v97
    v_mov_b32 v98, 0x3f80
    v_mov_b32 v99, 0x3f800000
    v_mov_b32 v100, 0
    v_cmp_eq_u32 vcc, 0, v97
    s_nop 1
    v_cndmask_b32 v52, v100, v98, vcc
    v_cmp_eq_u32 vcc, 1, v97
    s_nop 1
    v_cndmask_b32 v52, v52, v99, vcc
    v_cmp_eq_u32 vcc, 2, v97
    s_nop 1
    v_cndmask_b32 v53, v100, v98, vcc
    v_cmp_eq_u32 vcc, 3, v97
    s_nop 1
    v_cndmask_b32 v53, v53, v99, vcc
    v_cmp_eq_u32 vcc, 4, v97
    s_nop 1
    v_cndmask_b32 v54, v100, v98, vcc
    v_cmp_eq_u32 vcc, 5, v97
    s_nop 1
    v_cndmask_b32 v54, v54, v99, vcc
    v_cmp_eq_u32 vcc, 6, v97
    s_nop 1
    v_cndmask_b32 v55, v100, v98, vcc
    v_cmp_eq_u32 vcc, 7, v97
    s_nop 1
    v_cndmask_b32 v55, v55, v99, vcc
    v_add_u32 v97, 16, v97
    v_cmp_eq_u32 vcc, 0, v97
    s_nop 1
    v_cndmask_b32 v56, v100, v98, vcc
    v_cmp_eq_u32 vcc, 1, v97
    s_nop 1
    v_cndmask_b32 v56, v56, v99, vcc
    v_cmp_eq_u32 vcc, 2, v97
    s_nop 1
    v_cndmask_b32 v57, v100, v98, vcc
    v_cmp_eq_u32 vcc, 3, v97
    s_nop 1
    v_cndmask_b32 v57, v57, v99, vcc
    v_cmp_eq_u32 vcc, 4, v97
    s_nop 1
    v_cndmask_b32 v58, v100, v98, vcc
    v_cmp_eq_u32 vcc, 5, v97
    s_nop 1
    v_cndmask_b32 v58, v58, v99, vcc
    v_cmp_eq_u32 vcc, 6, v97
    s_nop 1
    v_cndmask_b32 v59, v100, v98, vcc
    v_cmp_eq_u32 vcc, 7, v97
    s_nop 1
    v_cndmask_b32 v59, v59, v99, vcc
    s_lshl_b32 s46, s49, 1
    s_add_u32 s46, s46, 0
    s_mul_hi_u32 s47, s46, 0x1c71c71d
    s_mul_i32 s50, s47, 9
    s_sub_u32 s50, s46, s50
    s_lshl_b32 s47, s47, 2
    s_add_u32 s47, s47, s48
    s_mul_i32 s47, s47, 9
    s_add_u32 s47, s47, s50
    s_mul_i32 s47, s47, 5120
    s_add_u32 s47, s47, 4423680
    v_add_u32 v10, s47, v1
    s_lshl_b32 s46, s49, 1
    s_add_u32 s46, s46, 1
    s_mul_hi_u32 s47, s46, 0x1c71c71d
    s_mul_i32 s50, s47, 9
    s_sub_u32 s50, s46, s50
    s_lshl_b32 s47, s47, 2
    s_add_u32 s47, s47, s48
    s_mul_i32 s47, s47, 9
    s_add_u32 s47, s47, s50
    s_mul_i32 s47, s47, 5120
    s_add_u32 s47, s47, 4423680
    v_add_u32 v11, s47, v1
    s_waitcnt vmcnt(0)
    v_mfma_f32_16x16x32_bf16 v[60:63], v[16:19], v[52:55], 0
    v_mfma_f32_16x16x32_bf16 v[64:67], v[20:23], v[52:55], 0
    v_mfma_f32_16x16x32_bf16 v[68:71], v[24:27], v[52:55], 0
    v_mfma_f32_16x16x32_bf16 v[72:75], v[28:31], v[52:55], 0
    v_mfma_f32_16x16x32_bf16 v[76:79], v[32:35], v[52:55], 0
    v_mfma_f32_16x16x32_bf16 v[80:83], v[36:39], v[52:55], 0
    v_mfma_f32_16x16x32_bf16 v[84:87], v[40:43], v[52:55], 0
    v_mfma_f32_16x16x32_bf16 v[88:91], v[44:47], v[52:55], 0
    v_mfma_f32_16x16x32_bf16 v[92:95], v[48:51], v[52:55], 0
    v_cvt_pk_bf16_f32 v60, v60, v61
    v_cvt_pk_bf16_f32 v61, v62, v63
    v_cvt_pk_bf16_f32 v62, v64, v65
    v_cvt_pk_bf16_f32 v63, v66, v67
    buffer_store_dwordx4 v[60:63], v10, s[16:19], 0 offen offset:0 sc1
    v_cvt_pk_bf16_f32 v68, v68, v69
    v_cvt_pk_bf16_f32 v69, v70, v71
    v_cvt_pk_bf16_f32 v70, v72, v73
    v_cvt_pk_bf16_f32 v71, v74, v75
    buffer_store_dwordx4 v[68:71], v10, s[16:19], 0 offen offset:1024 sc1
    v_cvt_pk_bf16_f32 v76, v76, v77
    v_cvt_pk_bf16_f32 v77, v78, v79
    v_cvt_pk_bf16_f32 v78, v80, v81
    v_cvt_pk_bf16_f32 v79, v82, v83
    buffer_store_dwordx4 v[76:79], v10, s[16:19], 0 offen offset:2048 sc1
    v_cvt_pk_bf16_f32 v84, v84, v85
    v_cvt_pk_bf16_f32 v85, v86, v87
    v_cvt_pk_bf16_f32 v86, v88, v89
    v_cvt_pk_bf16_f32 v87, v90, v91
    buffer_store_dwordx4 v[84:87], v10, s[16:19], 0 offen offset:3072 sc1
    v_cvt_pk_bf16_f32 v92, v92, 0
    v_cvt_pk_bf16_f32 v93, v93, 0
    v_cvt_pk_bf16_f32 v94, v94, 0
    v_cvt_pk_bf16_f32 v95, v95, 0
    s_mov_b32 s46, 4096
    buffer_store_dwordx4 v[92:95], v10, s[16:19], s46 offen sc1
    s_nop 1
    v_mfma_f32_16x16x32_bf16 v[60:63], v[16:19], v[56:59], 0
    v_mfma_f32_16x16x32_bf16 v[64:67], v[20:23], v[56:59], 0
    v_mfma_f32_16x16x32_bf16 v[68:71], v[24:27], v[56:59], 0
    v_mfma_f32_16x16x32_bf16 v[72:75], v[28:31], v[56:59], 0
    v_mfma_f32_16x16x32_bf16 v[76:79], v[32:35], v[56:59], 0
    v_mfma_f32_16x16x32_bf16 v[80:83], v[36:39], v[56:59], 0
    v_mfma_f32_16x16x32_bf16 v[84:87], v[40:43], v[56:59], 0
    v_mfma_f32_16x16x32_bf16 v[88:91], v[44:47], v[56:59], 0
    v_mfma_f32_16x16x32_bf16 v[92:95], v[48:51], v[56:59], 0
    v_cvt_pk_bf16_f32 v60, v60, v61
    v_cvt_pk_bf16_f32 v61, v62, v63
    v_cvt_pk_bf16_f32 v62, v64, v65
    v_cvt_pk_bf16_f32 v63, v66, v67
    buffer_store_dwordx4 v[60:63], v11, s[16:19], 0 offen offset:0 sc1
    v_cvt_pk_bf16_f32 v68, v68, v69
    v_cvt_pk_bf16_f32 v69, v70, v71
    v_cvt_pk_bf16_f32 v70, v72, v73
    v_cvt_pk_bf16_f32 v71, v74, v75
    buffer_store_dwordx4 v[68:71], v11, s[16:19], 0 offen offset:1024 sc1
    v_cvt_pk_bf16_f32 v76, v76, v77
    v_cvt_pk_bf16_f32 v77, v78, v79
    v_cvt_pk_bf16_f32 v78, v80, v81
    v_cvt_pk_bf16_f32 v79, v82, v83
    buffer_store_dwordx4 v[76:79], v11, s[16:19], 0 offen offset:2048 sc1
    v_cvt_pk_bf16_f32 v84, v84, v85
    v_cvt_pk_bf16_f32 v85, v86, v87
    v_cvt_pk_bf16_f32 v86, v88, v89
    v_cvt_pk_bf16_f32 v87, v90, v91
    buffer_store_dwordx4 v[84:87], v11, s[16:19], 0 offen offset:3072 sc1
    v_cvt_pk_bf16_f32 v92, v92, 0
    v_cvt_pk_bf16_f32 v93, v93, 0
    v_cvt_pk_bf16_f32 v94, v94, 0
    v_cvt_pk_bf16_f32 v95, v95, 0
    s_mov_b32 s46, 4096
    buffer_store_dwordx4 v[92:95], v11, s[16:19], s46 offen sc1
    s_nop 1
    s_branch S0_JOIN
S0_E:
    v_mov_b32 v14, 5197824
    buffer_load_dword v20, v14, s[16:19], 0 offen sc1
    s_waitcnt vmcnt(0)
    v_add_u32 v20, 1, v20
    s_nop 0
    v_readfirstlane_b32 s63, v20
    s_branch S0_JOIN
S0_M:
    s_cmp_lg_u32 s2, 200
    s_cbranch_scc1 S0_JOIN
    s_cmp_lg_u32 s3, 5
    s_cbranch_scc1 S0_JOIN
    s_mov_b32 s20, s38
    s_mov_b32 s21, s39
    s_mov_b32 s22, 1152
    s_mov_b32 s23, 0x20000
    v_lshlrev_b32 v14, 2, v0
    buffer_load_dword v16, v14, s[20:23], 0 offen offset:0
    buffer_load_dword v17, v14, s[20:23], 0 offen offset:256
    buffer_load_dword v18, v14, s[20:23], 0 offen offset:512
    buffer_load_dword v19, v14, s[20:23], 0 offen offset:768
    buffer_load_dword v20, v14, s[20:23], 0 offen offset:1024
    s_mov_b32 s46, 0x3f803f80
    v_mov_b32 v24, 0
    s_waitcnt vmcnt(0)
    v_dot2c_f32_bf16 v24, s46, v16
    v_dot2c_f32_bf16 v24, s46, v17
    v_dot2c_f32_bf16 v24, s46, v18
    v_dot2c_f32_bf16 v24, s46, v19
    v_dot2c_f32_bf16 v24, s46, v20
    s_nop 2
    v_add_f32_dpp v24, v24, v24 quad_perm:[1,0,3,2] row_mask:0xf bank_mask:0xf
    s_nop 1
    v_add_f32_dpp v24, v24, v24 quad_perm:[2,3,0,1] row_mask:0xf bank_mask:0xf
    s_nop 1
    v_add_f32_dpp v24, v24, v24 row_half_mirror row_mask:0xf bank_mask:0xf
    s_nop 1
    v_add_f32_dpp v24, v24, v24 row_mirror row_mask:0xf bank_mask:0xf
    v_mov_b32 v25, v24
    s_nop 1
    v_permlane16_swap_b32 v24, v25
    v_add_f32 v24, v24, v25
    v_mov_b32 v25, v24
    s_nop 1
    v_permlane32_swap_b32 v24, v25
    v_add_f32 v24, v24, v25
    s_mov_b32 s46, 0x3AE38E39
    v_mul_f32 v24, s46, v24
    v_lshlrev_b32 v14, 3, v0
    v_add_u32 v14, 5160960, v14
    v_lshlrev_b32 v26, 16, v16
    v_and_b32 v27, 0xffff0000, v16
    v_sub_f32 v26, v26, v24
    v_sub_f32 v27, v27, v24
    buffer_store_dwordx2 v[26:27], v14, s[16:19], 0 offen offset:0 sc1
    s_nop 1
    v_lshlrev_b32 v26, 16, v17
    v_and_b32 v27, 0xffff0000, v17
    v_sub_f32 v26, v26, v24
    v_sub_f32 v27, v27, v24
    buffer_store_dwordx2 v[26:27], v14, s[16:19], 0 offen offset:512 sc1
    s_nop 1
    v_lshlrev_b32 v26, 16, v18
    v_and_b32 v27, 0xffff0000, v18
    v_sub_f32 v26, v26, v24
    v_sub_f32 v27, v27, v24
    buffer_store_dwordx2 v[26:27], v14, s[16:19], 0 offen offset:1024 sc1
    s_nop 1
    v_lshlrev_b32 v26, 16, v19
    v_and_b32 v27, 0xffff0000, v19
    v_sub_f32 v26, v26, v24
    v_sub_f32 v27, v27, v24
    buffer_store_dwordx2 v[26:27], v14, s[16:19], 0 offen offset:1536 sc1
    s_nop 1
    v_lshlrev_b32 v26, 16, v20
    v_and_b32 v27, 0xffff0000, v20
    v_sub_f32 v26, v26, v24
    v_sub_f32 v27, v27, v24
    buffer_store_dwordx2 v[26:27], v14, s[16:19], 0 offen offset:2048 sc1
    s_nop 1
S0_JOIN:
    s_waitcnt vmcnt(0)
S0_BAR:
    s_barrier
    s_cmp_lg_u32 s3, 7
    s_cbranch_scc1 S0_NP_2
    s_lshl_b32 s46, s2, 7
    s_add_u32 s46, s46, 5165056
    v_mov_b32 v14, s46
    v_mov_b32 v15, s63
    s_mov_b64 exec, 1
    buffer_store_dword v15, v14, s[16:19], 0 offen sc1
    s_mov_b64 exec, -1
    v_and_b32 v16, 15, v0
    v_bfe_u32 v17, v0, 4, 1
    v_mov_b32 v18, s40
    v_mov_b32 v19, s41
    v_cmp_eq_u32 vcc, 0, v17
    s_nop 1
    v_cndmask_b32 v18, v16, v18, vcc
    v_cndmask_b32 v19, v19, v16, vcc
    v_and_b32 v20, 3, v18
    v_lshlrev_b32 v20, 3, v20
    v_and_b32 v21, 7, v19
    v_or_b32 v20, v20, v21
    v_lshlrev_b32 v20, 3, v20
    v_lshrrev_b32 v21, 2, v18
    v_lshl_or_b32 v20, v21, 1, v20
    v_lshrrev_b32 v21, 3, v19
    v_or_b32 v20, v20, v21
    v_lshlrev_b32 v20, 7, v20
    v_add_u32 v20, 5165056, v20
    s_mov_b32 s62, 3000
POLL_3:
    buffer_load_dword v21, v20, s[16:19], 0 offen sc1
    s_waitcnt vmcnt(0)
    v_cmp_ne_u32 vcc, s63, v21
    s_cbranch_vccz PDONE_4
    s_sub_u32 s62, s62, 1
    s_cbranch_scc1 PDONE_4
    s_sleep 1
    s_branch POLL_3
PDONE_4:
S0_NP_2:
    s_barrier
    s_cmp_ge_u32 s3, 4
    s_cbranch_scc1 K1_H
    s_lshl_b32 s46, s40, 3
    s_lshl_b32 s47, s55, 1
    s_add_u32 s46, s46, s47
    s_mul_i32 s46, s46, 18432
    v_add_u32 v5, s46, v1
    s_mov_b32 s49, 0
    buffer_load_dwordx4 a[0:3], v5, s[16:19], s49 offen offset:0
    s_mov_b32 s49, 18432
    buffer_load_dwordx4 a[72:75], v5, s[16:19], s49 offen offset:0
    s_mov_b32 s49, 0
    buffer_load_dwordx4 a[4:7], v5, s[16:19], s49 offen offset:1024
    s_mov_b32 s49, 18432
    buffer_load_dwordx4 a[76:79], v5, s[16:19], s49 offen offset:1024
    s_mov_b32 s49, 0
    buffer_load_dwordx4 a[8:11], v5, s[16:19], s49 offen offset:2048
    s_mov_b32 s49, 18432
    buffer_load_dwordx4 a[80:83], v5, s[16:19], s49 offen offset:2048
    s_mov_b32 s49, 0
    buffer_load_dwordx4 a[12:15], v5, s[16:19], s49 offen offset:3072
    s_mov_b32 s49, 18432
    buffer_load_dwordx4 a[84:87], v5, s[16:19], s49 offen offset:3072
    s_mov_b32 s49, 4096
    buffer_load_dwordx4 a[16:19], v5, s[16:19], s49 offen offset:0
    s_mov_b32 s49, 22528
    buffer_load_dwordx4 a[88:91], v5, s[16:19], s49 offen offset:0
    s_mov_b32 s20, s4
    s_mov_b32 s21, s5
    s_mov_b32 s22, 2359296
    s_mov_b32 s23, 0x20000
    s_mov_b32 s24, s14
    s_mov_b32 s25, s15
    s_mov_b32 s26, 2359296
    s_mov_b32 s27, 0x20000
    s_mov_b32 s28, s8
    s_mov_b32 s29, s9
    s_mov_b32 s30, 5308416
    s_mov_b32 s31, 0x20000
    s_mov_b32 s32, s10
    s_mov_b32 s33, s11
    s_mov_b32 s34, 5308416
    s_mov_b32 s35, 0x20000
    s_mov_b32 s36, s12
    s_mov_b32 s37, s13
    s_mov_b32 s38, 5308416
    s_mov_b32 s39, 0x20000
    v_add_u32 v6, 0x10000, v1
    s_barrier
    ds_read_b128 v[72:75], v1 offset:0
    ds_read_b128 v[76:79], v1 offset:1024
    ds_read_b128 v[80:83], v1 offset:2048
    ds_read_b128 v[84:87], v1 offset:3072
    ds_read_b128 v[88:91], v1 offset:4096
    s_waitcnt lgkmcnt(4)
    s_waitcnt vmcnt(8)
    v_mfma_f32_16x16x32_bf16 v[16:19], v[72:75], a[0:3], 0
    v_mfma_f32_16x16x32_bf16 v[20:23], v[72:75], a[72:75], 0
    ds_read_b128 v[92:95], v1 offset:5120
    s_waitcnt lgkmcnt(4)
    v_mfma_f32_16x16x32_bf16 v[24:27], v[76:79], a[0:3], 0
    v_mfma_f32_16x16x32_bf16 v[28:31], v[76:79], a[72:75], 0
    ds_read_b128 v[96:99], v1 offset:6144
    s_mov_b32 s49, 4096
    buffer_load_dwordx4 a[20:23], v5, s[16:19], s49 offen offset:1024
    s_waitcnt lgkmcnt(4)
    v_mfma_f32_16x16x32_bf16 v[32:35], v[80:83], a[0:3], 0
    v_mfma_f32_16x16x32_bf16 v[36:39], v[80:83], a[72:75], 0
    ds_read_b128 v[100:103], v1 offset:7168
    s_waitcnt lgkmcnt(4)
    v_mfma_f32_16x16x32_bf16 v[40:43], v[84:87], a[0:3], 0
    v_mfma_f32_16x16x32_bf16 v[44:47], v[84:87], a[72:75], 0
    ds_read_b128 v[104:107], v1 offset:8192
    s_mov_b32 s49, 22528
    buffer_load_dwordx4 a[92:95], v5, s[16:19], s49 offen offset:1024
    s_waitcnt lgkmcnt(4)
    v_mfma_f32_16x16x32_bf16 v[48:51], v[88:91], a[0:3], 0
    v_mfma_f32_16x16x32_bf16 v[52:55], v[88:91], a[72:75], 0
    ds_read_b128 v[108:111], v1 offset:9216
    s_waitcnt lgkmcnt(4)
    s_waitcnt vmcnt(8)
    v_mfma_f32_16x16x32_bf16 v[16:19], v[92:95], a[4:7], v[16:19]
    v_mfma_f32_16x16x32_bf16 v[20:23], v[92:95], a[76:79], v[20:23]
    ds_read_b128 v[72:75], v1 offset:10240
    s_waitcnt lgkmcnt(4)
    v_mfma_f32_16x16x32_bf16 v[24:27], v[96:99], a[4:7], v[24:27]
    v_mfma_f32_16x16x32_bf16 v[28:31], v[96:99], a[76:79], v[28:31]
    ds_read_b128 v[76:79], v1 offset:11264
    s_mov_b32 s49, 4096
    buffer_load_dwordx4 a[24:27], v5, s[16:19], s49 offen offset:2048
    s_waitcnt lgkmcnt(4)
    v_mfma_f32_16x16x32_bf16 v[32:35], v[100:103], a[4:7], v[32:35]
    v_mfma_f32_16x16x32_bf16 v[36:39], v[100:103], a[76:79], v[36:39]
    ds_read_b128 v[80:83], v1 offset:12288
    v_and_b32 v14, 1, v3
    s_waitcnt lgkmcnt(4)
    v_mfma_f32_16x16x32_bf16 v[40:43], v[104:107], a[4:7], v[40:43]
    v_mfma_f32_16x16x32_bf16 v[44:47], v[104:107], a[76:79], v[44:47]
    ds_read_b128 v[84:87], v1 offset:13312
    s_mov_b32 s49, 22528
    buffer_load_dwordx4 a[96:99], v5, s[16:19], s49 offen offset:2048
    s_waitcnt lgkmcnt(4)
    v_mfma_f32_16x16x32_bf16 v[48:51], v[108:111], a[4:7], v[48:51]
    v_mfma_f32_16x16x32_bf16 v[52:55], v[108:111], a[76:79], v[52:55]
    ds_read_b128 v[88:91], v1 offset:14336
    v_cmp_eq_u32 vcc, 0, v14
    s_waitcnt lgkmcnt(4)
    s_waitcnt vmcnt(8)
    v_mfma_f32_16x16x32_bf16 v[16:19], v[72:75], a[8:11], v[16:19]
    v_mfma_f32_16x16x32_bf16 v[20:23], v[72:75], a[80:83], v[20:23]
    s_barrier
    ds_read_b128 v[92:95], v1 offset:15360
    s_waitcnt lgkmcnt(4)
    v_mfma_f32_16x16x32_bf16 v[24:27], v[76:79], a[8:11], v[24:27]
    v_mfma_f32_16x16x32_bf16 v[28:31], v[76:79], a[80:83], v[28:31]
    ds_read_b128 v[96:99], v1 offset:16384
    s_mov_b32 s49, 4096
    buffer_load_dwordx4 a[28:31], v5, s[16:19], s49 offen offset:3072
    s_waitcnt lgkmcnt(4)
    v_mfma_f32_16x16x32_bf16 v[32:35], v[80:83], a[8:11], v[32:35]
    v_mfma_f32_16x16x32_bf16 v[36:39], v[80:83], a[80:83], v[36:39]
    ds_read_b128 v[100:103], v1 offset:17408
    v_mov_b32 v15, 1.0
    s_waitcnt lgkmcnt(4)
    v_mfma_f32_16x16x32_bf16 v[40:43], v[84:87], a[8:11], v[40:43]
    v_mfma_f32_16x16x32_bf16 v[44:47], v[84:87], a[80:83], v[44:47]
    ds_read_b128 v[104:107], v1 offset:18432
    s_mov_b32 s49, 22528
    buffer_load_dwordx4 a[100:103], v5, s[16:19], s49 offen offset:3072
    s_waitcnt lgkmcnt(4)
    v_mfma_f32_16x16x32_bf16 v[48:51], v[88:91], a[8:11], v[48:51]
    v_mfma_f32_16x16x32_bf16 v[52:55], v[88:91], a[80:83], v[52:55]
    ds_read_b128 v[108:111], v1 offset:19456
    s_nop 0
    s_waitcnt lgkmcnt(4)
    s_waitcnt vmcnt(8)
    v_mfma_f32_16x16x32_bf16 v[16:19], v[92:95], a[12:15], v[16:19]
    v_mfma_f32_16x16x32_bf16 v[20:23], v[92:95], a[84:87], v[20:23]
    ds_read_b128 v[72:75], v1 offset:20480
    s_waitcnt lgkmcnt(4)
    v_mfma_f32_16x16x32_bf16 v[24:27], v[96:99], a[12:15], v[24:27]
    v_mfma_f32_16x16x32_bf16 v[28:31], v[96:99], a[84:87], v[28:31]
    ds_read_b128 v[76:79], v1 offset:21504
    s_mov_b32 s49, 8192
    buffer_load_dwordx4 a[32:35], v5, s[16:19], s49 offen offset:0
    s_waitcnt lgkmcnt(4)
    v_mfma_f32_16x16x32_bf16 v[32:35], v[100:103], a[12:15], v[32:35]
    v_mfma_f32_16x16x32_bf16 v[36:39], v[100:103], a[84:87], v[36:39]
    ds_read_b128 v[80:83], v1 offset:22528
    v_cndmask_b32 v7, 0, v15, vcc
    s_waitcnt lgkmcnt(4)
    v_mfma_f32_16x16x32_bf16 v[40:43], v[104:107], a[12:15], v[40:43]
    v_mfma_f32_16x16x32_bf16 v[44:47], v[104:107], a[84:87], v[44:47]
    ds_read_b128 v[84:87], v1 offset:23552
    s_mov_b32 s49, 26624
    buffer_load_dwordx4 a[104:107], v5, s[16:19], s49 offen offset:0
    s_waitcnt lgkmcnt(4)
    v_mfma_f32_16x16x32_bf16 v[48:51], v[108:111], a[12:15], v[48:51]
    v_mfma_f32_16x16x32_bf16 v[52:55], v[108:111], a[84:87], v[52:55]
    ds_read_b128 v[88:91], v1 offset:24576
    s_lshl_b32 s46, s55, 5
    s_waitcnt lgkmcnt(4)
    s_waitcnt vmcnt(8)
    v_mfma_f32_16x16x32_bf16 v[16:19], v[72:75], a[16:19], v[16:19]
    v_mfma_f32_16x16x32_bf16 v[20:23], v[72:75], a[88:91], v[20:23]
    ds_read_b128 v[92:95], v1 offset:25600
    s_waitcnt lgkmcnt(4)
    v_mfma_f32_16x16x32_bf16 v[24:27], v[76:79], a[16:19], v[24:27]
    v_mfma_f32_16x16x32_bf16 v[28:31], v[76:79], a[88:91], v[28:31]
    ds_read_b128 v[96:99], v1 offset:26624
    s_mov_b32 s49, 8192
    buffer_load_dwordx4 a[36:39], v5, s[16:19], s49 offen offset:1024
    s_waitcnt lgkmcnt(4)
    v_mfma_f32_16x16x32_bf16 v[32:35], v[80:83], a[16:19], v[32:35]
    v_mfma_f32_16x16x32_bf16 v[36:39], v[80:83], a[88:91], v[36:39]
    ds_read_b128 v[100:103], v1 offset:27648
    v_add_u32 v8, s46, v2
    s_waitcnt lgkmcnt(4)
    v_mfma_f32_16x16x32_bf16 v[40:43], v[84:87], a[16:19], v[40:43]
    v_mfma_f32_16x16x32_bf16 v[44:47], v[84:87], a[88:91], v[44:47]
    ds_read_b128 v[104:107], v1 offset:28672
    s_mov_b32 s49, 26624
    buffer_load_dwordx4 a[108:111], v5, s[16:19], s49 offen offset:1024
    s_waitcnt lgkmcnt(4)
    v_mfma_f32_16x16x32_bf16 v[48:51], v[88:91], a[16:19], v[48:51]
    v_mfma_f32_16x16x32_bf16 v[52:55], v[88:91], a[88:91], v[52:55]
    ds_read_b128 v[108:111], v1 offset:29696
    v_mul_u32_u24 v8, 288, v8
    s_waitcnt lgkmcnt(4)
    s_waitcnt vmcnt(8)
    v_mfma_f32_16x16x32_bf16 v[16:19], v[92:95], a[20:23], v[16:19]
    v_mfma_f32_16x16x32_bf16 v[20:23], v[92:95], a[92:95], v[20:23]
    s_barrier
    ds_read_b128 v[72:75], v1 offset:30720
    s_waitcnt lgkmcnt(4)
    v_mfma_f32_16x16x32_bf16 v[24:27], v[96:99], a[20:23], v[24:27]
    v_mfma_f32_16x16x32_bf16 v[28:31], v[96:99], a[92:95], v[28:31]
    ds_read_b128 v[76:79], v1 offset:31744
    s_mov_b32 s49, 8192
    buffer_load_dwordx4 a[40:43], v5, s[16:19], s49 offen offset:2048
    s_waitcnt lgkmcnt(4)
    v_mfma_f32_16x16x32_bf16 v[32:35], v[100:103], a[20:23], v[32:35]
    v_mfma_f32_16x16x32_bf16 v[36:39], v[100:103], a[92:95], v[36:39]
    ds_read_b128 v[80:83], v1 offset:32768
    v_lshl_add_u32 v8, v3, 6, v8
    s_waitcnt lgkmcnt(4)
    v_mfma_f32_16x16x32_bf16 v[40:43], v[104:107], a[20:23], v[40:43]
    v_mfma_f32_16x16x32_bf16 v[44:47], v[104:107], a[92:95], v[44:47]
    ds_read_b128 v[84:87], v1 offset:33792
    s_mov_b32 s49, 26624
    buffer_load_dwordx4 a[112:115], v5, s[16:19], s49 offen offset:2048
    s_waitcnt lgkmcnt(4)
    v_mfma_f32_16x16x32_bf16 v[48:51], v[108:111], a[20:23], v[48:51]
    v_mfma_f32_16x16x32_bf16 v[52:55], v[108:111], a[92:95], v[52:55]
    ds_read_b128 v[88:91], v1 offset:34816
    s_waitcnt lgkmcnt(4)
    s_waitcnt vmcnt(8)
    v_mfma_f32_16x16x32_bf16 v[16:19], v[72:75], a[24:27], v[16:19]
    v_mfma_f32_16x16x32_bf16 v[20:23], v[72:75], a[96:99], v[20:23]
    ds_read_b128 v[92:95], v1 offset:35840
    s_waitcnt lgkmcnt(4)
    v_mfma_f32_16x16x32_bf16 v[24:27], v[76:79], a[24:27], v[24:27]
    v_mfma_f32_16x16x32_bf16 v[28:31], v[76:79], a[96:99], v[28:31]
    ds_read_b128 v[96:99], v1 offset:36864
    s_mov_b32 s49, 8192
    buffer_load_dwordx4 a[44:47], v5, s[16:19], s49 offen offset:3072
    s_waitcnt lgkmcnt(4)
    v_mfma_f32_16x16x32_bf16 v[32:35], v[80:83], a[24:27], v[32:35]
    v_mfma_f32_16x16x32_bf16 v[36:39], v[80:83], a[96:99], v[36:39]
    ds_read_b128 v[100:103], v1 offset:37888
    s_waitcnt lgkmcnt(4)
    v_mfma_f32_16x16x32_bf16 v[40:43], v[84:87], a[24:27], v[40:43]
    v_mfma_f32_16x16x32_bf16 v[44:47], v[84:87], a[96:99], v[44:47]
    ds_read_b128 v[104:107], v1 offset:38912
    s_mov_b32 s49, 26624
    buffer_load_dwordx4 a[116:119], v5, s[16:19], s49 offen offset:3072
    s_waitcnt lgkmcnt(4)
    v_mfma_f32_16x16x32_bf16 v[48:51], v[88:91], a[24:27], v[48:51]
    v_mfma_f32_16x16x32_bf16 v[52:55], v[88:91], a[96:99], v[52:55]
    ds_read_b128 v[108:111], v1 offset:39936
    s_waitcnt lgkmcnt(4)
    s_waitcnt vmcnt(8)
    v_mfma_f32_16x16x32_bf16 v[16:19], v[92:95], a[28:31], v[16:19]
    v_mfma_f32_16x16x32_bf16 v[20:23], v[92:95], a[100:103], v[20:23]
    ds_read_b128 v[72:75], v1 offset:40960
    s_waitcnt lgkmcnt(4)
    v_mfma_f32_16x16x32_bf16 v[24:27], v[96:99], a[28:31], v[24:27]
    v_mfma_f32_16x16x32_bf16 v[28:31], v[96:99], a[100:103], v[28:31]
    ds_read_b128 v[76:79], v1 offset:41984
    s_mov_b32 s49, 12288
    buffer_load_dwordx4 a[48:51], v5, s[16:19], s49 offen offset:0
    s_waitcnt lgkmcnt(4)
    v_mfma_f32_16x16x32_bf16 v[32:35], v[100:103], a[28:31], v[32:35]
    v_mfma_f32_16x16x32_bf16 v[36:39], v[100:103], a[100:103], v[36:39]
    ds_read_b128 v[80:83], v1 offset:43008
    s_waitcnt lgkmcnt(4)
    v_mfma_f32_16x16x32_bf16 v[40:43], v[104:107], a[28:31], v[40:43]
    v_mfma_f32_16x16x32_bf16 v[44:47], v[104:107], a[100:103], v[44:47]
    ds_read_b128 v[84:87], v1 offset:44032
    s_mov_b32 s49, 30720
    buffer_load_dwordx4 a[120:123], v5, s[16:19], s49 offen offset:0
    s_waitcnt lgkmcnt(4)
    v_mfma_f32_16x16x32_bf16 v[48:51], v[108:111], a[28:31], v[48:51]
    v_mfma_f32_16x16x32_bf16 v[52:55], v[108:111], a[100:103], v[52:55]
    ds_read_b128 v[88:91], v1 offset:45056
    s_waitcnt lgkmcnt(4)
    s_waitcnt vmcnt(8)
    v_mfma_f32_16x16x32_bf16 v[16:19], v[72:75], a[32:35], v[16:19]
    v_mfma_f32_16x16x32_bf16 v[20:23], v[72:75], a[104:107], v[20:23]
    s_barrier
    ds_read_b128 v[92:95], v1 offset:46080
    s_waitcnt lgkmcnt(4)
    v_mfma_f32_16x16x32_bf16 v[24:27], v[76:79], a[32:35], v[24:27]
    v_mfma_f32_16x16x32_bf16 v[28:31], v[76:79], a[104:107], v[28:31]
    ds_read_b128 v[96:99], v1 offset:47104
    s_mov_b32 s49, 12288
    buffer_load_dwordx4 a[52:55], v5, s[16:19], s49 offen offset:1024
    s_waitcnt lgkmcnt(4)
    v_mfma_f32_16x16x32_bf16 v[32:35], v[80:83], a[32:35], v[32:35]
    v_mfma_f32_16x16x32_bf16 v[36:39], v[80:83], a[104:107], v[36:39]
    ds_read_b128 v[100:103], v1 offset:48128
    s_waitcnt lgkmcnt(4)
    v_mfma_f32_16x16x32_bf16 v[40:43], v[84:87], a[32:35], v[40:43]
    v_mfma_f32_16x16x32_bf16 v[44:47], v[84:87], a[104:107], v[44:47]
    ds_read_b128 v[104:107], v1 offset:49152
    s_mov_b32 s49, 30720
    buffer_load_dwordx4 a[124:127], v5, s[16:19], s49 offen offset:1024
    s_waitcnt lgkmcnt(4)
    v_mfma_f32_16x16x32_bf16 v[48:51], v[88:91], a[32:35], v[48:51]
    v_mfma_f32_16x16x32_bf16 v[52:55], v[88:91], a[104:107], v[52:55]
    ds_read_b128 v[108:111], v1 offset:50176
    s_waitcnt lgkmcnt(4)
    s_waitcnt vmcnt(8)
    v_mfma_f32_16x16x32_bf16 v[16:19], v[92:95], a[36:39], v[16:19]
    v_mfma_f32_16x16x32_bf16 v[20:23], v[92:95], a[108:111], v[20:23]
    ds_read_b128 v[72:75], v1 offset:51200
    s_waitcnt lgkmcnt(4)
    v_mfma_f32_16x16x32_bf16 v[24:27], v[96:99], a[36:39], v[24:27]
    v_mfma_f32_16x16x32_bf16 v[28:31], v[96:99], a[108:111], v[28:31]
    ds_read_b128 v[76:79], v1 offset:52224
    s_mov_b32 s49, 12288
    buffer_load_dwordx4 a[56:59], v5, s[16:19], s49 offen offset:2048
    s_waitcnt lgkmcnt(4)
    v_mfma_f32_16x16x32_bf16 v[32:35], v[100:103], a[36:39], v[32:35]
    v_mfma_f32_16x16x32_bf16 v[36:39], v[100:103], a[108:111], v[36:39]
    ds_read_b128 v[80:83], v1 offset:53248
    s_waitcnt lgkmcnt(4)
    v_mfma_f32_16x16x32_bf16 v[40:43], v[104:107], a[36:39], v[40:43]
    v_mfma_f32_16x16x32_bf16 v[44:47], v[104:107], a[108:111], v[44:47]
    ds_read_b128 v[84:87], v1 offset:54272
    s_mov_b32 s49, 30720
    buffer_load_dwordx4 a[128:131], v5, s[16:19], s49 offen offset:2048
    s_waitcnt lgkmcnt(4)
    v_mfma_f32_16x16x32_bf16 v[48:51], v[108:111], a[36:39], v[48:51]
    v_mfma_f32_16x16x32_bf16 v[52:55], v[108:111], a[108:111], v[52:55]
    ds_read_b128 v[88:91], v1 offset:55296
    s_waitcnt lgkmcnt(4)
    s_waitcnt vmcnt(8)
    v_mfma_f32_16x16x32_bf16 v[16:19], v[72:75], a[40:43], v[16:19]
    v_mfma_f32_16x16x32_bf16 v[20:23], v[72:75], a[112:115], v[20:23]
    ds_read_b128 v[92:95], v1 offset:56320
    s_waitcnt lgkmcnt(4)
    v_mfma_f32_16x16x32_bf16 v[24:27], v[76:79], a[40:43], v[24:27]
    v_mfma_f32_16x16x32_bf16 v[28:31], v[76:79], a[112:115], v[28:31]
    ds_read_b128 v[96:99], v1 offset:57344
    s_mov_b32 s49, 12288
    buffer_load_dwordx4 a[60:63], v5, s[16:19], s49 offen offset:3072
    s_waitcnt lgkmcnt(4)
    v_mfma_f32_16x16x32_bf16 v[32:35], v[80:83], a[40:43], v[32:35]
    v_mfma_f32_16x16x32_bf16 v[36:39], v[80:83], a[112:115], v[36:39]
    ds_read_b128 v[100:103], v1 offset:58368
    s_waitcnt lgkmcnt(4)
    v_mfma_f32_16x16x32_bf16 v[40:43], v[84:87], a[40:43], v[40:43]
    v_mfma_f32_16x16x32_bf16 v[44:47], v[84:87], a[112:115], v[44:47]
    ds_read_b128 v[104:107], v1 offset:59392
    s_mov_b32 s49, 30720
    buffer_load_dwordx4 a[132:135], v5, s[16:19], s49 offen offset:3072
    s_waitcnt lgkmcnt(4)
    v_mfma_f32_16x16x32_bf16 v[48:51], v[88:91], a[40:43], v[48:51]
    v_mfma_f32_16x16x32_bf16 v[52:55], v[88:91], a[112:115], v[52:55]
    ds_read_b128 v[108:111], v1 offset:60416
    s_waitcnt lgkmcnt(4)
    s_waitcnt vmcnt(8)
    v_mfma_f32_16x16x32_bf16 v[16:19], v[92:95], a[44:47], v[16:19]
    v_mfma_f32_16x16x32_bf16 v[20:23], v[92:95], a[116:119], v[20:23]
    s_barrier
    ds_read_b128 v[72:75], v1 offset:61440
    s_waitcnt lgkmcnt(4)
    v_mfma_f32_16x16x32_bf16 v[24:27], v[96:99], a[44:47], v[24:27]
    v_mfma_f32_16x16x32_bf16 v[28:31], v[96:99], a[116:119], v[28:31]
    ds_read_b128 v[76:79], v1 offset:62464
    s_mov_b32 s49, 16384
    buffer_load_dwordx4 a[64:67], v5, s[16:19], s49 offen offset:0
    s_waitcnt lgkmcnt(4)
    v_mfma_f32_16x16x32_bf16 v[32:35], v[100:103], a[44:47], v[32:35]
    v_mfma_f32_16x16x32_bf16 v[36:39], v[100:103], a[116:119], v[36:39]
    ds_read_b128 v[80:83], v1 offset:63488
    s_waitcnt lgkmcnt(4)
    v_mfma_f32_16x16x32_bf16 v[40:43], v[104:107], a[44:47], v[40:43]
    v_mfma_f32_16x16x32_bf16 v[44:47], v[104:107], a[116:119], v[44:47]
    ds_read_b128 v[84:87], v1 offset:64512
    s_mov_b32 s49, 34816
    buffer_load_dwordx4 a[136:139], v5, s[16:19], s49 offen offset:0
    s_waitcnt lgkmcnt(4)
    v_mfma_f32_16x16x32_bf16 v[48:51], v[108:111], a[44:47], v[48:51]
    v_mfma_f32_16x16x32_bf16 v[52:55], v[108:111], a[116:119], v[52:55]
    ds_read_b128 v[88:91], v6 offset:0
    s_waitcnt lgkmcnt(4)
    s_waitcnt vmcnt(8)
    v_mfma_f32_16x16x32_bf16 v[16:19], v[72:75], a[48:51], v[16:19]
    v_mfma_f32_16x16x32_bf16 v[20:23], v[72:75], a[120:123], v[20:23]
    ds_read_b128 v[92:95], v6 offset:1024
    s_waitcnt lgkmcnt(4)
    v_mfma_f32_16x16x32_bf16 v[24:27], v[76:79], a[48:51], v[24:27]
    v_mfma_f32_16x16x32_bf16 v[28:31], v[76:79], a[120:123], v[28:31]
    ds_read_b128 v[96:99], v6 offset:2048
    s_mov_b32 s49, 16384
    buffer_load_dwordx4 a[68:71], v5, s[16:19], s49 offen offset:1024
    s_waitcnt lgkmcnt(4)
    v_mfma_f32_16x16x32_bf16 v[32:35], v[80:83], a[48:51], v[32:35]
    v_mfma_f32_16x16x32_bf16 v[36:39], v[80:83], a[120:123], v[36:39]
    ds_read_b128 v[100:103], v6 offset:3072
    s_waitcnt lgkmcnt(4)
    v_mfma_f32_16x16x32_bf16 v[40:43], v[84:87], a[48:51], v[40:43]
    v_mfma_f32_16x16x32_bf16 v[44:47], v[84:87], a[120:123], v[44:47]
    ds_read_b128 v[104:107], v6 offset:4096
    s_mov_b32 s49, 34816
    buffer_load_dwordx4 a[140:143], v5, s[16:19], s49 offen offset:1024
    s_waitcnt lgkmcnt(4)
    v_mfma_f32_16x16x32_bf16 v[48:51], v[88:91], a[48:51], v[48:51]
    v_mfma_f32_16x16x32_bf16 v[52:55], v[88:91], a[120:123], v[52:55]
    ds_read_b128 v[108:111], v6 offset:5120
    s_waitcnt lgkmcnt(4)
    s_waitcnt vmcnt(8)
    v_mfma_f32_16x16x32_bf16 v[16:19], v[92:95], a[52:55], v[16:19]
    v_mfma_f32_16x16x32_bf16 v[20:23], v[92:95], a[124:127], v[20:23]
    ds_read_b128 v[72:75], v6 offset:6144
    s_waitcnt lgkmcnt(4)
    v_mfma_f32_16x16x32_bf16 v[24:27], v[96:99], a[52:55], v[24:27]
    v_mfma_f32_16x16x32_bf16 v[28:31], v[96:99], a[124:127], v[28:31]
    ds_read_b128 v[76:79], v6 offset:7168
    s_waitcnt lgkmcnt(4)
    v_mfma_f32_16x16x32_bf16 v[32:35], v[100:103], a[52:55], v[32:35]
    v_mfma_f32_16x16x32_bf16 v[36:39], v[100:103], a[124:127], v[36:39]
    ds_read_b128 v[80:83], v6 offset:8192
    s_waitcnt lgkmcnt(4)
    v_mfma_f32_16x16x32_bf16 v[40:43], v[104:107], a[52:55], v[40:43]
    v_mfma_f32_16x16x32_bf16 v[44:47], v[104:107], a[124:127], v[44:47]
    ds_read_b128 v[84:87], v6 offset:9216
    s_waitcnt lgkmcnt(4)
    v_mfma_f32_16x16x32_bf16 v[48:51], v[108:111], a[52:55], v[48:51]
    v_mfma_f32_16x16x32_bf16 v[52:55], v[108:111], a[124:127], v[52:55]
    ds_read_b128 v[88:91], v6 offset:10240
    s_waitcnt lgkmcnt(4)
    s_waitcnt vmcnt(6)
    v_mfma_f32_16x16x32_bf16 v[16:19], v[72:75], a[56:59], v[16:19]
    v_mfma_f32_16x16x32_bf16 v[20:23], v[72:75], a[128:131], v[20:23]
    ds_read_b128 v[92:95], v6 offset:11264
    s_waitcnt lgkmcnt(4)
    v_mfma_f32_16x16x32_bf16 v[24:27], v[76:79], a[56:59], v[24:27]
    v_mfma_f32_16x16x32_bf16 v[28:31], v[76:79], a[128:131], v[28:31]
    ds_read_b128 v[96:99], v6 offset:12288
    s_waitcnt lgkmcnt(4)
    v_mfma_f32_16x16x32_bf16 v[32:35], v[80:83], a[56:59], v[32:35]
    v_mfma_f32_16x16x32_bf16 v[36:39], v[80:83], a[128:131], v[36:39]
    ds_read_b128 v[100:103], v6 offset:13312
    s_waitcnt lgkmcnt(4)
    v_mfma_f32_16x16x32_bf16 v[40:43], v[84:87], a[56:59], v[40:43]
    v_mfma_f32_16x16x32_bf16 v[44:47], v[84:87], a[128:131], v[44:47]
    ds_read_b128 v[104:107], v6 offset:14336
    s_waitcnt lgkmcnt(4)
    v_mfma_f32_16x16x32_bf16 v[48:51], v[88:91], a[56:59], v[48:51]
    v_mfma_f32_16x16x32_bf16 v[52:55], v[88:91], a[128:131], v[52:55]
    ds_read_b128 v[108:111], v6 offset:15360
    s_waitcnt lgkmcnt(4)
    s_waitcnt vmcnt(4)
    v_mfma_f32_16x16x32_bf16 v[16:19], v[92:95], a[60:63], v[16:19]
    v_mfma_f32_16x16x32_bf16 v[20:23], v[92:95], a[132:135], v[20:23]
    s_barrier
    ds_read_b128 v[72:75], v6 offset:16384
    s_waitcnt lgkmcnt(4)
    v_mfma_f32_16x16x32_bf16 v[24:27], v[96:99], a[60:63], v[24:27]
    v_mfma_f32_16x16x32_bf16 v[28:31], v[96:99], a[132:135], v[28:31]
    ds_read_b128 v[76:79], v6 offset:17408
    s_waitcnt lgkmcnt(4)
    v_mfma_f32_16x16x32_bf16 v[32:35], v[100:103], a[60:63], v[32:35]
    v_mfma_f32_16x16x32_bf16 v[36:39], v[100:103], a[132:135], v[36:39]
    ds_read_b128 v[80:83], v6 offset:18432
    s_waitcnt lgkmcnt(4)
    v_mfma_f32_16x16x32_bf16 v[40:43], v[104:107], a[60:63], v[40:43]
    v_mfma_f32_16x16x32_bf16 v[44:47], v[104:107], a[132:135], v[44:47]
    ds_read_b128 v[84:87], v6 offset:19456
    s_waitcnt lgkmcnt(4)
    v_mfma_f32_16x16x32_bf16 v[48:51], v[108:111], a[60:63], v[48:51]
    v_mfma_f32_16x16x32_bf16 v[52:55], v[108:111], a[132:135], v[52:55]
    ds_read_b128 v[88:91], v6 offset:20480
    s_waitcnt lgkmcnt(4)
    s_waitcnt vmcnt(2)
    v_mfma_f32_16x16x32_bf16 v[16:19], v[72:75], a[64:67], v[16:19]
    v_mfma_f32_16x16x32_bf16 v[20:23], v[72:75], a[136:139], v[20:23]
    ds_read_b128 v[92:95], v6 offset:21504
    s_waitcnt lgkmcnt(4)
    v_mfma_f32_16x16x32_bf16 v[24:27], v[76:79], a[64:67], v[24:27]
    v_mfma_f32_16x16x32_bf16 v[28:31], v[76:79], a[136:139], v[28:31]
    ds_read_b128 v[96:99], v6 offset:22528
    s_waitcnt lgkmcnt(4)
    v_mfma_f32_16x16x32_bf16 v[32:35], v[80:83], a[64:67], v[32:35]
    v_mfma_f32_16x16x32_bf16 v[36:39], v[80:83], a[136:139], v[36:39]
    ds_read_b128 v[100:103], v6 offset:23552
    s_waitcnt lgkmcnt(4)
    v_mfma_f32_16x16x32_bf16 v[40:43], v[84:87], a[64:67], v[40:43]
    v_mfma_f32_16x16x32_bf16 v[44:47], v[84:87], a[136:139], v[44:47]
    ds_read_b128 v[104:107], v6 offset:24576
    s_waitcnt lgkmcnt(4)
    v_mfma_f32_16x16x32_bf16 v[48:51], v[88:91], a[64:67], v[48:51]
    v_mfma_f32_16x16x32_bf16 v[52:55], v[88:91], a[136:139], v[52:55]
    ds_read_b128 v[108:111], v6 offset:25600
    s_waitcnt lgkmcnt(4)
    s_waitcnt vmcnt(0)
    v_mfma_f32_16x16x32_bf16 v[16:19], v[92:95], a[68:71], v[16:19]
    v_mfma_f32_16x16x32_bf16 v[20:23], v[92:95], a[140:143], v[20:23]
    s_waitcnt lgkmcnt(3)
    v_mfma_f32_16x16x32_bf16 v[24:27], v[96:99], a[68:71], v[24:27]
    v_mfma_f32_16x16x32_bf16 v[28:31], v[96:99], a[140:143], v[28:31]
    s_waitcnt lgkmcnt(2)
    v_mfma_f32_16x16x32_bf16 v[32:35], v[100:103], a[68:71], v[32:35]
    v_mfma_f32_16x16x32_bf16 v[36:39], v[100:103], a[140:143], v[36:39]
    s_waitcnt lgkmcnt(1)
    v_mfma_f32_16x16x32_bf16 v[40:43], v[104:107], a[68:71], v[40:43]
    v_mfma_f32_16x16x32_bf16 v[44:47], v[104:107], a[140:143], v[44:47]
    s_waitcnt lgkmcnt(0)
    v_mfma_f32_16x16x32_bf16 v[48:51], v[108:111], a[68:71], v[48:51]
    v_mfma_f32_16x16x32_bf16 v[52:55], v[108:111], a[140:143], v[52:55]
    s_barrier
    v_max3_f32 v106, v16, v17, v18
    v_min3_f32 v107, v16, v17, v18
    v_max3_f32 v108, v19, v24, v25
    v_min3_f32 v109, v19, v24, v25
    v_max3_f32 v106, v106, v26, v27
    v_min3_f32 v107, v107, v26, v27
    v_max3_f32 v106, v106, v108, v32
    v_min3_f32 v107, v107, v109, v32
    v_mov_b32 v108, v106
    v_mov_b32 v109, v107
    s_nop 0
    v_permlane16_swap_b32 v106, v108
    v_permlane16_swap_b32 v107, v109
    v_max_f32 v106, v106, v108
    v_min_f32 v107, v107, v109
    v_sub_f32 v88, v16, v106
    v_sub_f32 v89, v107, v16
    v_sub_f32 v90, v17, v106
    v_sub_f32 v91, v107, v17
    v_sub_f32 v92, v18, v106
    v_sub_f32 v93, v107, v18
    v_sub_f32 v94, v19, v106
    v_sub_f32 v95, v107, v19
    v_sub_f32 v96, v24, v106
    v_sub_f32 v97, v107, v24
    v_sub_f32 v98, v25, v106
    v_sub_f32 v99, v107, v25
    v_sub_f32 v100, v26, v106
    v_sub_f32 v101, v107, v26
    v_sub_f32 v102, v27, v106
    v_sub_f32 v103, v107, v27
    v_sub_f32 v104, v32, v106
    v_sub_f32 v105, v107, v32
    v_exp_f32 v88, v88
    v_exp_f32 v89, v89
    v_exp_f32 v90, v90
    v_exp_f32 v91, v91
    v_exp_f32 v92, v92
    v_exp_f32 v93, v93
    v_exp_f32 v94, v94
    v_exp_f32 v95, v95
    v_exp_f32 v96, v96
    v_exp_f32 v97, v97
    v_exp_f32 v98, v98
    v_exp_f32 v99, v99
    v_exp_f32 v100, v100
    v_exp_f32 v101, v101
    v_exp_f32 v102, v102
    v_exp_f32 v103, v103
    v_exp_f32 v104, v104
    v_exp_f32 v105, v105
    v_pk_add_f32 v[106:107], v[88:89], v[90:91]
    v_pk_add_f32 v[108:109], v[92:93], v[94:95]
    v_pk_add_f32 v[106:107], v[106:107], v[96:97]
    v_pk_add_f32 v[108:109], v[108:109], v[98:99]
    v_pk_add_f32 v[106:107], v[106:107], v[100:101]
    v_pk_add_f32 v[108:109], v[108:109], v[102:103]
    v_pk_add_f32 v[106:107], v[106:107], v[104:105]
    v_pk_add_f32 v[106:107], v[106:107], v[108:109]
    v_mov_b32 v108, v106
    v_mov_b32 v109, v107
    s_nop 0
    v_permlane16_swap_b32 v106, v108
    v_permlane16_swap_b32 v107, v109
    v_pk_add_f32 v[106:107], v[106:107], v[108:109]
    v_rcp_f32 v106, v106
    v_rcp_f32 v107, v107
    s_nop 0
    v_pk_mul_f32 v[88:89], v[88:89], v[106:107]
    v_pk_mul_f32 v[90:91], v[90:91], v[106:107]
    v_pk_mul_f32 v[92:93], v[92:93], v[106:107]
    v_pk_mul_f32 v[94:95], v[94:95], v[106:107]
    v_pk_mul_f32 v[96:97], v[96:97], v[106:107]
    v_pk_mul_f32 v[98:99], v[98:99], v[106:107]
    v_pk_mul_f32 v[100:101], v[100:101], v[106:107]
    v_pk_mul_f32 v[102:103], v[102:103], v[106:107]
    v_pk_mul_f32 v[104:105], v[104:105], v[106:107]
    v_cvt_pk_bf16_f32 v72, v88, v90
    v_cvt_pk_bf16_f32 v73, v92, v94
    v_cvt_pk_bf16_f32 v74, v96, v98
    v_cvt_pk_bf16_f32 v75, v100, v102
    v_cvt_pk_bf16_f32 v76, v104, 0
    v_cvt_pk_bf16_f32 v77, v89, v91
    v_cvt_pk_bf16_f32 v78, v93, v95
    v_cvt_pk_bf16_f32 v79, v97, v99
    v_cvt_pk_bf16_f32 v80, v101, v103
    v_cvt_pk_bf16_f32 v81, v105, 0
    v_cvt_pk_bf16_f32 v82, v33, v34
    v_cvt_pk_bf16_f32 v83, v35, v40
    v_cvt_pk_bf16_f32 v84, v41, v42
    v_cvt_pk_bf16_f32 v85, v43, v48
    v_cvt_pk_bf16_f32 v86, v49, v7
    v_mov_b32 v87, 0
    ds_write_b128 v8, v[72:75] offset:0
    ds_write_b128 v8, v[76:79] offset:16
    ds_write_b128 v8, v[80:83] offset:32
    ds_write_b128 v8, v[84:87] offset:48
    s_waitcnt lgkmcnt(0)
    v_max3_f32 v106, v20, v21, v22
    v_min3_f32 v107, v20, v21, v22
    v_max3_f32 v108, v23, v28, v29
    v_min3_f32 v109, v23, v28, v29
    v_max3_f32 v106, v106, v30, v31
    v_min3_f32 v107, v107, v30, v31
    v_max3_f32 v106, v106, v108, v36
    v_min3_f32 v107, v107, v109, v36
    v_mov_b32 v108, v106
    v_mov_b32 v109, v107
    s_nop 0
    v_permlane16_swap_b32 v106, v108
    v_permlane16_swap_b32 v107, v109
    v_max_f32 v106, v106, v108
    v_min_f32 v107, v107, v109
    v_sub_f32 v88, v20, v106
    v_sub_f32 v89, v107, v20
    v_sub_f32 v90, v21, v106
    v_sub_f32 v91, v107, v21
    v_sub_f32 v92, v22, v106
    v_sub_f32 v93, v107, v22
    v_sub_f32 v94, v23, v106
    v_sub_f32 v95, v107, v23
    v_sub_f32 v96, v28, v106
    v_sub_f32 v97, v107, v28
    v_sub_f32 v98, v29, v106
    v_sub_f32 v99, v107, v29
    v_sub_f32 v100, v30, v106
    v_sub_f32 v101, v107, v30
    v_sub_f32 v102, v31, v106
    v_sub_f32 v103, v107, v31
    v_sub_f32 v104, v36, v106
    v_sub_f32 v105, v107, v36
    v_exp_f32 v88, v88
    v_exp_f32 v89, v89
    v_exp_f32 v90, v90
    v_exp_f32 v91, v91
    v_exp_f32 v92, v92
    v_exp_f32 v93, v93
    v_exp_f32 v94, v94
    v_exp_f32 v95, v95
    v_exp_f32 v96, v96
    v_exp_f32 v97, v97
    v_exp_f32 v98, v98
    v_exp_f32 v99, v99
    v_exp_f32 v100, v100
    v_exp_f32 v101, v101
    v_exp_f32 v102, v102
    v_exp_f32 v103, v103
    v_exp_f32 v104, v104
    v_exp_f32 v105, v105
    v_pk_add_f32 v[106:107], v[88:89], v[90:91]
    v_pk_add_f32 v[108:109], v[92:93], v[94:95]
    v_pk_add_f32 v[106:107], v[106:107], v[96:97]
    v_pk_add_f32 v[108:109], v[108:109], v[98:99]
    v_pk_add_f32 v[106:107], v[106:107], v[100:101]
    v_pk_add_f32 v[108:109], v[108:109], v[102:103]
    v_pk_add_f32 v[106:107], v[106:107], v[104:105]
    v_pk_add_f32 v[106:107], v[106:107], v[108:109]
    v_mov_b32 v108, v106
    v_mov_b32 v109, v107
    s_nop 0
    v_permlane16_swap_b32 v106, v108
    v_permlane16_swap_b32 v107, v109
    v_pk_add_f32 v[106:107], v[106:107], v[108:109]
    v_rcp_f32 v106, v106
    v_rcp_f32 v107, v107
    s_nop 0
    v_pk_mul_f32 v[88:89], v[88:89], v[106:107]
    v_pk_mul_f32 v[90:91], v[90:91], v[106:107]
    v_pk_mul_f32 v[92:93], v[92:93], v[106:107]
    v_pk_mul_f32 v[94:95], v[94:95], v[106:107]
    v_pk_mul_f32 v[96:97], v[96:97], v[106:107]
    v_pk_mul_f32 v[98:99], v[98:99], v[106:107]
    v_pk_mul_f32 v[100:101], v[100:101], v[106:107]
    v_pk_mul_f32 v[102:103], v[102:103], v[106:107]
    v_pk_mul_f32 v[104:105], v[104:105], v[106:107]
    v_cvt_pk_bf16_f32 v72, v88, v90
    v_cvt_pk_bf16_f32 v73, v92, v94
    v_cvt_pk_bf16_f32 v74, v96, v98
    v_cvt_pk_bf16_f32 v75, v100, v102
    v_cvt_pk_bf16_f32 v76, v104, 0
    v_cvt_pk_bf16_f32 v77, v89, v91
    v_cvt_pk_bf16_f32 v78, v93, v95
    v_cvt_pk_bf16_f32 v79, v97, v99
    v_cvt_pk_bf16_f32 v80, v101, v103
    v_cvt_pk_bf16_f32 v81, v105, 0
    v_cvt_pk_bf16_f32 v82, v37, v38
    v_cvt_pk_bf16_f32 v83, v39, v44
    v_cvt_pk_bf16_f32 v84, v45, v46
    v_cvt_pk_bf16_f32 v85, v47, v52
    v_cvt_pk_bf16_f32 v86, v53, v7
    v_mov_b32 v87, 0
    ds_write_b128 v8, v[72:75] offset:4608
    ds_write_b128 v8, v[76:79] offset:4624
    ds_write_b128 v8, v[80:83] offset:4640
    ds_write_b128 v8, v[84:87] offset:4656
    s_waitcnt lgkmcnt(0)
    s_barrier
    ds_read_b128 v[72:75], v6 offset:26624
    ds_read_b128 v[76:79], v6 offset:27648
    s_waitcnt lgkmcnt(1)
    v_mfma_f32_16x16x32_bf16 v[56:59], v[72:75], a[0:3], 0
    v_mfma_f32_16x16x32_bf16 v[60:63], v[72:75], a[72:75], 0
    ds_read_b128 v[80:83], v6 offset:28672
    s_waitcnt lgkmcnt(1)
    v_mfma_f32_16x16x32_bf16 v[64:67], v[76:79], a[0:3], 0
    v_mfma_f32_16x16x32_bf16 v[68:71], v[76:79], a[72:75], 0
    ds_read_b128 v[84:87], v6 offset:29696
    s_waitcnt lgkmcnt(1)
    v_mfma_f32_16x16x32_bf16 v[56:59], v[80:83], a[4:7], v[56:59]
    v_mfma_f32_16x16x32_bf16 v[60:63], v[80:83], a[76:79], v[60:63]
    ds_read_b128 v[72:75], v6 offset:30720
    s_waitcnt lgkmcnt(1)
    v_mfma_f32_16x16x32_bf16 v[64:67], v[84:87], a[4:7], v[64:67]
    v_mfma_f32_16x16x32_bf16 v[68:71], v[84:87], a[76:79], v[68:71]
    ds_read_b128 v[76:79], v6 offset:31744
    s_waitcnt lgkmcnt(1)
    v_mfma_f32_16x16x32_bf16 v[56:59], v[72:75], a[8:11], v[56:59]
    v_mfma_f32_16x16x32_bf16 v[60:63], v[72:75], a[80:83], v[60:63]
    ds_read_b128 v[80:83], v6 offset:32768
    s_waitcnt lgkmcnt(1)
    v_mfma_f32_16x16x32_bf16 v[64:67], v[76:79], a[8:11], v[64:67]
    v_mfma_f32_16x16x32_bf16 v[68:71], v[76:79], a[80:83], v[68:71]
    ds_read_b128 v[84:87], v6 offset:33792
    s_waitcnt lgkmcnt(1)
    v_mfma_f32_16x16x32_bf16 v[56:59], v[80:83], a[12:15], v[56:59]
    v_mfma_f32_16x16x32_bf16 v[60:63], v[80:83], a[84:87], v[60:63]
    ds_read_b128 v[72:75], v6 offset:34816
    s_waitcnt lgkmcnt(1)
    v_mfma_f32_16x16x32_bf16 v[64:67], v[84:87], a[12:15], v[64:67]
    v_mfma_f32_16x16x32_bf16 v[68:71], v[84:87], a[84:87], v[68:71]
    ds_read_b128 v[76:79], v6 offset:35840
    s_waitcnt lgkmcnt(1)
    v_mfma_f32_16x16x32_bf16 v[56:59], v[72:75], a[16:19], v[56:59]
    v_mfma_f32_16x16x32_bf16 v[60:63], v[72:75], a[88:91], v[60:63]
    ds_read_b128 v[80:83], v6 offset:36864
    s_waitcnt lgkmcnt(1)
    v_mfma_f32_16x16x32_bf16 v[64:67], v[76:79], a[16:19], v[64:67]
    v_mfma_f32_16x16x32_bf16 v[68:71], v[76:79], a[88:91], v[68:71]
    ds_read_b128 v[84:87], v6 offset:37888
    s_waitcnt lgkmcnt(1)
    v_mfma_f32_16x16x32_bf16 v[56:59], v[80:83], a[20:23], v[56:59]
    v_mfma_f32_16x16x32_bf16 v[60:63], v[80:83], a[92:95], v[60:63]
    ds_read_b128 v[72:75], v6 offset:38912
    s_waitcnt lgkmcnt(1)
    v_mfma_f32_16x16x32_bf16 v[64:67], v[84:87], a[20:23], v[64:67]
    v_mfma_f32_16x16x32_bf16 v[68:71], v[84:87], a[92:95], v[68:71]
    ds_read_b128 v[76:79], v6 offset:39936
    s_waitcnt lgkmcnt(1)
    v_mfma_f32_16x16x32_bf16 v[56:59], v[72:75], a[24:27], v[56:59]
    v_mfma_f32_16x16x32_bf16 v[60:63], v[72:75], a[96:99], v[60:63]
    ds_read_b128 v[80:83], v6 offset:40960
    s_waitcnt lgkmcnt(1)
    v_mfma_f32_16x16x32_bf16 v[64:67], v[76:79], a[24:27], v[64:67]
    v_mfma_f32_16x16x32_bf16 v[68:71], v[76:79], a[96:99], v[68:71]
    ds_read_b128 v[84:87], v6 offset:41984
    s_waitcnt lgkmcnt(1)
    v_mfma_f32_16x16x32_bf16 v[56:59], v[80:83], a[28:31], v[56:59]
    v_mfma_f32_16x16x32_bf16 v[60:63], v[80:83], a[100:103], v[60:63]
    ds_read_b128 v[72:75], v6 offset:43008
    s_waitcnt lgkmcnt(1)
    v_mfma_f32_16x16x32_bf16 v[64:67], v[84:87], a[28:31], v[64:67]
    v_mfma_f32_16x16x32_bf16 v[68:71], v[84:87], a[100:103], v[68:71]
    ds_read_b128 v[76:79], v6 offset:44032
    s_waitcnt lgkmcnt(1)
    v_mfma_f32_16x16x32_bf16 v[56:59], v[72:75], a[32:35], v[56:59]
    v_mfma_f32_16x16x32_bf16 v[60:63], v[72:75], a[104:107], v[60:63]
    ds_read_b128 v[80:83], v6 offset:45056
    s_waitcnt lgkmcnt(1)
    v_mfma_f32_16x16x32_bf16 v[64:67], v[76:79], a[32:35], v[64:67]
    v_mfma_f32_16x16x32_bf16 v[68:71], v[76:79], a[104:107], v[68:71]
    ds_read_b128 v[84:87], v6 offset:46080
    s_waitcnt lgkmcnt(1)
    v_mfma_f32_16x16x32_bf16 v[56:59], v[80:83], a[36:39], v[56:59]
    v_mfma_f32_16x16x32_bf16 v[60:63], v[80:83], a[108:111], v[60:63]
    ds_read_b128 v[72:75], v6 offset:47104
    s_waitcnt lgkmcnt(1)
    v_mfma_f32_16x16x32_bf16 v[64:67], v[84:87], a[36:39], v[64:67]
    v_mfma_f32_16x16x32_bf16 v[68:71], v[84:87], a[108:111], v[68:71]
    ds_read_b128 v[76:79], v6 offset:48128
    s_waitcnt lgkmcnt(1)
    v_mfma_f32_16x16x32_bf16 v[56:59], v[72:75], a[40:43], v[56:59]
    v_mfma_f32_16x16x32_bf16 v[60:63], v[72:75], a[112:115], v[60:63]
    ds_read_b128 v[80:83], v6 offset:49152
    s_waitcnt lgkmcnt(1)
    v_mfma_f32_16x16x32_bf16 v[64:67], v[76:79], a[40:43], v[64:67]
    v_mfma_f32_16x16x32_bf16 v[68:71], v[76:79], a[112:115], v[68:71]
    ds_read_b128 v[84:87], v6 offset:50176
    s_waitcnt lgkmcnt(1)
    v_mfma_f32_16x16x32_bf16 v[56:59], v[80:83], a[44:47], v[56:59]
    v_mfma_f32_16x16x32_bf16 v[60:63], v[80:83], a[116:119], v[60:63]
    ds_read_b128 v[72:75], v6 offset:51200
    s_waitcnt lgkmcnt(1)
    v_mfma_f32_16x16x32_bf16 v[64:67], v[84:87], a[44:47], v[64:67]
    v_mfma_f32_16x16x32_bf16 v[68:71], v[84:87], a[116:119], v[68:71]
    ds_read_b128 v[76:79], v6 offset:52224
    s_waitcnt lgkmcnt(1)
    v_mfma_f32_16x16x32_bf16 v[56:59], v[72:75], a[48:51], v[56:59]
    v_mfma_f32_16x16x32_bf16 v[60:63], v[72:75], a[120:123], v[60:63]
    ds_read_b128 v[80:83], v6 offset:53248
    s_waitcnt lgkmcnt(1)
    v_mfma_f32_16x16x32_bf16 v[64:67], v[76:79], a[48:51], v[64:67]
    v_mfma_f32_16x16x32_bf16 v[68:71], v[76:79], a[120:123], v[68:71]
    ds_read_b128 v[84:87], v6 offset:54272
    s_waitcnt lgkmcnt(1)
    v_mfma_f32_16x16x32_bf16 v[56:59], v[80:83], a[52:55], v[56:59]
    v_mfma_f32_16x16x32_bf16 v[60:63], v[80:83], a[124:127], v[60:63]
    ds_read_b128 v[72:75], v6 offset:55296
    s_waitcnt lgkmcnt(1)
    v_mfma_f32_16x16x32_bf16 v[64:67], v[84:87], a[52:55], v[64:67]
    v_mfma_f32_16x16x32_bf16 v[68:71], v[84:87], a[124:127], v[68:71]
    ds_read_b128 v[76:79], v6 offset:56320
    s_waitcnt lgkmcnt(1)
    v_mfma_f32_16x16x32_bf16 v[56:59], v[72:75], a[56:59], v[56:59]
    v_mfma_f32_16x16x32_bf16 v[60:63], v[72:75], a[128:131], v[60:63]
    ds_read_b128 v[80:83], v6 offset:57344
    s_waitcnt lgkmcnt(1)
    v_mfma_f32_16x16x32_bf16 v[64:67], v[76:79], a[56:59], v[64:67]
    v_mfma_f32_16x16x32_bf16 v[68:71], v[76:79], a[128:131], v[68:71]
    ds_read_b128 v[84:87], v6 offset:58368
    s_waitcnt lgkmcnt(1)
    v_mfma_f32_16x16x32_bf16 v[56:59], v[80:83], a[60:63], v[56:59]
    v_mfma_f32_16x16x32_bf16 v[60:63], v[80:83], a[132:135], v[60:63]
    ds_read_b128 v[72:75], v6 offset:59392
    s_waitcnt lgkmcnt(1)
    v_mfma_f32_16x16x32_bf16 v[64:67], v[84:87], a[60:63], v[64:67]
    v_mfma_f32_16x16x32_bf16 v[68:71], v[84:87], a[132:135], v[68:71]
    ds_read_b128 v[76:79], v6 offset:60416
    s_waitcnt lgkmcnt(1)
    v_mfma_f32_16x16x32_bf16 v[56:59], v[72:75], a[64:67], v[56:59]
    v_mfma_f32_16x16x32_bf16 v[60:63], v[72:75], a[136:139], v[60:63]
    ds_read_b128 v[80:83], v6 offset:61440
    s_waitcnt lgkmcnt(1)
    v_mfma_f32_16x16x32_bf16 v[64:67], v[76:79], a[64:67], v[64:67]
    v_mfma_f32_16x16x32_bf16 v[68:71], v[76:79], a[136:139], v[68:71]
    ds_read_b128 v[84:87], v6 offset:62464
    s_waitcnt lgkmcnt(1)
    v_mfma_f32_16x16x32_bf16 v[56:59], v[80:83], a[68:71], v[56:59]
    v_mfma_f32_16x16x32_bf16 v[60:63], v[80:83], a[140:143], v[60:63]
    s_waitcnt lgkmcnt(0)
    v_mfma_f32_16x16x32_bf16 v[64:67], v[84:87], a[68:71], v[64:67]
    v_mfma_f32_16x16x32_bf16 v[68:71], v[84:87], a[140:143], v[68:71]
    v_lshrrev_b32 v100, 2, v2
    v_and_b32 v101, 3, v2
    v_lshrrev_b32 v102, 1, v100
    v_and_b32 v100, 1, v100
    v_lshrrev_b32 v103, 1, v3
    v_cmp_eq_u32 s[52:53], v102, v103
    v_mul_u32_u24 v102, 24, v102
    v_and_b32 v103, 1, v3
    v_mul_u32_u24 v103, 48, v103
    v_add_u32 v103, 147456, v103
    v_mov_b32 v104, 152064
    v_add_u32 v14, 0, v101
    v_mad_u32_u24 v15, v100, 12, v14
    v_cmp_eq_u32 vcc, 9, v14
    s_nop 1
    v_cndmask_b32 v15, v15, v14, vcc
    v_add_u32 v15, v102, v15
    v_mul_u32_u24 v15, 96, v15
    v_add_u32 v15, v15, v103
    v_cmp_ge_u32 vcc, 9, v14
    s_and_b64 vcc, vcc, s[52:53]
    s_nop 0
    v_cndmask_b32 v9, v104, v15, vcc
    v_add_u32 v14, 4, v101
    v_mad_u32_u24 v15, v100, 12, v14
    v_cmp_eq_u32 vcc, 9, v14
    s_nop 1
    v_cndmask_b32 v15, v15, v14, vcc
    v_add_u32 v15, v102, v15
    v_mul_u32_u24 v15, 96, v15
    v_add_u32 v15, v15, v103
    v_cmp_ge_u32 vcc, 9, v14
    s_and_b64 vcc, vcc, s[52:53]
    s_nop 0
    v_cndmask_b32 v10, v104, v15, vcc
    v_add_u32 v14, 8, v101
    v_mad_u32_u24 v15, v100, 12, v14
    v_cmp_eq_u32 vcc, 9, v14
    s_nop 1
    v_cndmask_b32 v15, v15, v14, vcc
    v_add_u32 v15, v102, v15
    v_mul_u32_u24 v15, 96, v15
    v_add_u32 v15, v15, v103
    v_cmp_ge_u32 vcc, 9, v14
    s_and_b64 vcc, vcc, s[52:53]
    s_nop 0
    v_cndmask_b32 v11, v104, v15, vcc
    s_lshl_b32 s46, s40, 3
    s_lshl_b32 s47, s55, 1
    s_add_u32 s46, s46, s47
    s_lshl_b32 s46, s46, 4
    s_add_u32 s46, s46, s41
    s_lshl_b32 s47, s46, 10
    s_add_u32 s47, s47, 6774784
    v_add_u32 v12, s47, v1
    s_lshl_b32 s47, s46, 8
    s_add_u32 s47, s47, 8871936
    v_lshlrev_b32 v13, 2, v0
    v_add_u32 v13, s47, v13
    v_max3_f32 v106, v50, v51, v56
    v_min3_f32 v107, v50, v51, v56
    v_max3_f32 v108, v57, v58, v59
    v_min3_f32 v109, v57, v58, v59
    v_max3_f32 v106, v106, v64, v65
    v_min3_f32 v107, v107, v64, v65
    v_max3_f32 v106, v106, v108, v66
    v_min3_f32 v107, v107, v109, v66
    v_mov_b32 v108, v106
    v_mov_b32 v109, v107
    s_nop 0
    v_permlane16_swap_b32 v106, v108
    v_permlane16_swap_b32 v107, v109
    v_max_f32 v106, v106, v108
    v_min_f32 v107, v107, v109
    v_sub_f32 v88, v50, v106
    v_sub_f32 v89, v107, v50
    v_sub_f32 v90, v51, v106
    v_sub_f32 v91, v107, v51
    v_sub_f32 v92, v56, v106
    v_sub_f32 v93, v107, v56
    v_sub_f32 v94, v57, v106
    v_sub_f32 v95, v107, v57
    v_sub_f32 v96, v58, v106
    v_sub_f32 v97, v107, v58
    v_sub_f32 v98, v59, v106
    v_sub_f32 v99, v107, v59
    v_sub_f32 v100, v64, v106
    v_sub_f32 v101, v107, v64
    v_sub_f32 v102, v65, v106
    v_sub_f32 v103, v107, v65
    v_sub_f32 v104, v66, v106
    v_sub_f32 v105, v107, v66
    v_exp_f32 v88, v88
    v_exp_f32 v89, v89
    v_exp_f32 v90, v90
    v_exp_f32 v91, v91
    v_exp_f32 v92, v92
    v_exp_f32 v93, v93
    v_exp_f32 v94, v94
    v_exp_f32 v95, v95
    v_exp_f32 v96, v96
    v_exp_f32 v97, v97
    v_exp_f32 v98, v98
    v_exp_f32 v99, v99
    v_exp_f32 v100, v100
    v_exp_f32 v101, v101
    v_exp_f32 v102, v102
    v_exp_f32 v103, v103
    v_exp_f32 v104, v104
    v_exp_f32 v105, v105
    v_pk_add_f32 v[106:107], v[88:89], v[90:91]
    v_pk_add_f32 v[108:109], v[92:93], v[94:95]
    v_pk_add_f32 v[106:107], v[106:107], v[96:97]
    v_pk_add_f32 v[108:109], v[108:109], v[98:99]
    v_pk_add_f32 v[106:107], v[106:107], v[100:101]
    v_pk_add_f32 v[108:109], v[108:109], v[102:103]
    v_pk_add_f32 v[106:107], v[106:107], v[104:105]
    v_pk_add_f32 v[106:107], v[106:107], v[108:109]
    v_mov_b32 v108, v106
    v_mov_b32 v109, v107
    s_nop 0
    v_permlane16_swap_b32 v106, v108
    v_permlane16_swap_b32 v107, v109
    v_pk_add_f32 v[106:107], v[106:107], v[108:109]
    v_rcp_f32 v106, v106
    v_rcp_f32 v107, v107
    s_nop 0
    v_pk_mul_f32 v[88:89], v[88:89], v[106:107]
    v_pk_mul_f32 v[90:91], v[90:91], v[106:107]
    v_pk_mul_f32 v[92:93], v[92:93], v[106:107]
    v_pk_mul_f32 v[94:95], v[94:95], v[106:107]
    v_pk_mul_f32 v[96:97], v[96:97], v[106:107]
    v_pk_mul_f32 v[98:99], v[98:99], v[106:107]
    v_pk_mul_f32 v[100:101], v[100:101], v[106:107]
    v_pk_mul_f32 v[102:103], v[102:103], v[106:107]
    v_pk_mul_f32 v[104:105], v[104:105], v[106:107]
    v_cvt_pk_bf16_f32 v16, v88, v90
    v_cvt_pk_bf16_f32 v17, v92, v94
    v_cvt_pk_bf16_f32 v18, v96, v98
    v_cvt_pk_bf16_f32 v19, v100, v102
    v_cvt_pk_bf16_f32 v20, v104, 0
    v_cvt_pk_bf16_f32 v21, v89, v91
    v_cvt_pk_bf16_f32 v22, v93, v95
    v_cvt_pk_bf16_f32 v23, v97, v99
    v_cvt_pk_bf16_f32 v24, v101, v103
    v_cvt_pk_bf16_f32 v25, v105, 0
    v_mov_b32 v26, 0
    v_mov_b32 v27, 0
    v_max3_f32 v106, v54, v55, v60
    v_min3_f32 v107, v54, v55, v60
    v_max3_f32 v108, v61, v62, v63
    v_min3_f32 v109, v61, v62, v63
    v_max3_f32 v106, v106, v68, v69
    v_min3_f32 v107, v107, v68, v69
    v_max3_f32 v106, v106, v108, v70
    v_min3_f32 v107, v107, v109, v70
    v_mov_b32 v108, v106
    v_mov_b32 v109, v107
    s_nop 0
    v_permlane16_swap_b32 v106, v108
    v_permlane16_swap_b32 v107, v109
    v_max_f32 v106, v106, v108
    v_min_f32 v107, v107, v109
    v_sub_f32 v88, v54, v106
    v_sub_f32 v89, v107, v54
    v_sub_f32 v90, v55, v106
    v_sub_f32 v91, v107, v55
    v_sub_f32 v92, v60, v106
    v_sub_f32 v93, v107, v60
    v_sub_f32 v94, v61, v106
    v_sub_f32 v95, v107, v61
    v_sub_f32 v96, v62, v106
    v_sub_f32 v97, v107, v62
    v_sub_f32 v98, v63, v106
    v_sub_f32 v99, v107, v63
    v_sub_f32 v100, v68, v106
    v_sub_f32 v101, v107, v68
    v_sub_f32 v102, v69, v106
    v_sub_f32 v103, v107, v69
    v_sub_f32 v104, v70, v106
    v_sub_f32 v105, v107, v70
    v_exp_f32 v88, v88
    v_exp_f32 v89, v89
    v_exp_f32 v90, v90
    v_exp_f32 v91, v91
    v_exp_f32 v92, v92
    v_exp_f32 v93, v93
    v_exp_f32 v94, v94
    v_exp_f32 v95, v95
    v_exp_f32 v96, v96
    v_exp_f32 v97, v97
    v_exp_f32 v98, v98
    v_exp_f32 v99, v99
    v_exp_f32 v100, v100
    v_exp_f32 v101, v101
    v_exp_f32 v102, v102
    v_exp_f32 v103, v103
    v_exp_f32 v104, v104
    v_exp_f32 v105, v105
    v_pk_add_f32 v[106:107], v[88:89], v[90:91]
    v_pk_add_f32 v[108:109], v[92:93], v[94:95]
    v_pk_add_f32 v[106:107], v[106:107], v[96:97]
    v_pk_add_f32 v[108:109], v[108:109], v[98:99]
    v_pk_add_f32 v[106:107], v[106:107], v[100:101]
    v_pk_add_f32 v[108:109], v[108:109], v[102:103]
    v_pk_add_f32 v[106:107], v[106:107], v[104:105]
    v_pk_add_f32 v[106:107], v[106:107], v[108:109]
    v_mov_b32 v108, v106
    v_mov_b32 v109, v107
    s_nop 0
    v_permlane16_swap_b32 v106, v108
    v_permlane16_swap_b32 v107, v109
    v_pk_add_f32 v[106:107], v[106:107], v[108:109]
    v_rcp_f32 v106, v106
    v_rcp_f32 v107, v107
    s_nop 0
    v_pk_mul_f32 v[88:89], v[88:89], v[106:107]
    v_pk_mul_f32 v[90:91], v[90:91], v[106:107]
    v_pk_mul_f32 v[92:93], v[92:93], v[106:107]
    v_pk_mul_f32 v[94:95], v[94:95], v[106:107]
    v_pk_mul_f32 v[96:97], v[96:97], v[106:107]
    v_pk_mul_f32 v[98:99], v[98:99], v[106:107]
    v_pk_mul_f32 v[100:101], v[100:101], v[106:107]
    v_pk_mul_f32 v[102:103], v[102:103], v[106:107]
    v_pk_mul_f32 v[104:105], v[104:105], v[106:107]
    v_cvt_pk_bf16_f32 v28, v88, v90
    v_cvt_pk_bf16_f32 v29, v92, v94
    v_cvt_pk_bf16_f32 v30, v96, v98
    v_cvt_pk_bf16_f32 v31, v100, v102
    v_cvt_pk_bf16_f32 v32, v104, 0
    v_cvt_pk_bf16_f32 v33, v89, v91
    v_cvt_pk_bf16_f32 v34, v93, v95
    v_cvt_pk_bf16_f32 v35, v97, v99
    v_cvt_pk_bf16_f32 v36, v101, v103
    v_cvt_pk_bf16_f32 v37, v105, 0
    v_mov_b32 v38, 0
    v_mov_b32 v39, 0
    s_barrier
    ds_read_b128 v[40:43], v9 offset:0
    ds_read_b128 v[44:47], v9 offset:16
    ds_read_b128 v[48:51], v9 offset:32
    ds_read_b128 v[52:55], v10 offset:0
    ds_read_b128 v[56:59], v10 offset:16
    ds_read_b128 v[60:63], v10 offset:32
    ds_read_b128 v[64:67], v11 offset:0
    ds_read_b128 v[68:71], v11 offset:16
    ds_read_b128 v[72:75], v11 offset:32
    s_waitcnt lgkmcnt(6)
    v_mfma_f32_16x16x32_bf16 v[76:79], v[40:43], v[16:19], 0
    v_mfma_f32_16x16x32_bf16 v[76:79], v[44:47], v[20:23], v[76:79]
    v_mfma_f32_16x16x32_bf16 v[76:79], v[48:51], v[24:27], v[76:79]
    s_waitcnt lgkmcnt(3)
    v_mfma_f32_16x16x32_bf16 v[80:83], v[52:55], v[16:19], 0
    v_mfma_f32_16x16x32_bf16 v[80:83], v[56:59], v[20:23], v[80:83]
    v_mfma_f32_16x16x32_bf16 v[80:83], v[60:63], v[24:27], v[80:83]
    s_waitcnt lgkmcnt(0)
    v_mfma_f32_16x16x32_bf16 v[84:87], v[64:67], v[16:19], 0
    v_mfma_f32_16x16x32_bf16 v[84:87], v[68:71], v[20:23], v[84:87]
    v_mfma_f32_16x16x32_bf16 v[84:87], v[72:75], v[24:27], v[84:87]
    v_mfma_f32_16x16x32_bf16 v[88:91], v[40:43], v[28:31], 0
    v_mfma_f32_16x16x32_bf16 v[88:91], v[44:47], v[32:35], v[88:91]
    v_mfma_f32_16x16x32_bf16 v[88:91], v[48:51], v[36:39], v[88:91]
    v_mfma_f32_16x16x32_bf16 v[92:95], v[52:55], v[28:31], 0
    v_mfma_f32_16x16x32_bf16 v[92:95], v[56:59], v[32:35], v[92:95]
    v_mfma_f32_16x16x32_bf16 v[92:95], v[60:63], v[36:39], v[92:95]
    v_mfma_f32_16x16x32_bf16 v[96:99], v[64:67], v[28:31], 0
    v_mfma_f32_16x16x32_bf16 v[96:99], v[68:71], v[32:35], v[96:99]
    v_mfma_f32_16x16x32_bf16 v[96:99], v[72:75], v[36:39], v[96:99]
    v_add_f32 v14, 0x358637bd, v85
    v_rcp_f32 v14, v14
    s_nop 0
    v_mul_f32 v76, v76, v14
    v_mul_f32 v77, v77, v14
    v_mul_f32 v78, v78, v14
    v_mul_f32 v79, v79, v14
    v_mul_f32 v80, v80, v14
    v_mul_f32 v81, v81, v14
    v_mul_f32 v82, v82, v14
    v_mul_f32 v83, v83, v14
    v_mul_f32 v84, v84, v14
    v_cvt_pk_bf16_f32 v40, v76, v77
    v_cvt_pk_bf16_f32 v41, v78, v79
    v_cvt_pk_bf16_f32 v42, v80, v81
    v_cvt_pk_bf16_f32 v43, v82, v83
    v_cvt_pk_bf16_f32 v44, v84, 0
    s_mov_b32 s46, 0
    s_mov_b32 s47, 0
    buffer_store_dwordx4 v[40:43], v12, s[16:19], s46 offen sc1
    buffer_store_dword v44, v13, s[16:19], s47 offen sc1
    v_add_f32 v14, 0x358637bd, v97
    v_rcp_f32 v14, v14
    s_nop 0
    v_mul_f32 v88, v88, v14
    v_mul_f32 v89, v89, v14
    v_mul_f32 v90, v90, v14
    v_mul_f32 v91, v91, v14
    v_mul_f32 v92, v92, v14
    v_mul_f32 v93, v93, v14
    v_mul_f32 v94, v94, v14
    v_mul_f32 v95, v95, v14
    v_mul_f32 v96, v96, v14
    v_cvt_pk_bf16_f32 v48, v88, v89
    v_cvt_pk_bf16_f32 v49, v90, v91
    v_cvt_pk_bf16_f32 v50, v92, v93
    v_cvt_pk_bf16_f32 v51, v94, v95
    v_cvt_pk_bf16_f32 v52, v96, 0
    s_mov_b32 s46, 16384
    s_mov_b32 s47, 4096
    buffer_store_dwordx4 v[48:51], v12, s[16:19], s46 offen sc1
    buffer_store_dword v52, v13, s[16:19], s47 offen sc1
    s_lshl_b32 s46, s43, 2
    s_add_u32 s46, s46, s55
    s_mul_i32 s46, s46, 9
    s_add_u32 s46, s46, 6
    s_mul_i32 s46, s46, 5120
    s_add_u32 s46, s46, 4423680
    v_add_u32 v14, s46, v1
    s_mov_b32 s47, 0
    buffer_load_dwordx4 a[0:3], v14, s[16:19], s47 offen offset:0
    buffer_load_dwordx4 a[4:7], v14, s[16:19], s47 offen offset:1024
    buffer_load_dwordx4 a[8:11], v14, s[16:19], s47 offen offset:2048
    buffer_load_dwordx4 a[12:15], v14, s[16:19], s47 offen offset:3072
    s_mov_b32 s47, 4096
    buffer_load_dwordx4 a[16:19], v14, s[16:19], s47 offen offset:0
    buffer_load_dwordx4 a[20:23], v14, s[16:19], s47 offen offset:1024
    buffer_load_dwordx4 a[24:27], v14, s[16:19], s47 offen offset:2048
    buffer_load_dwordx4 a[28:31], v14, s[16:19], s47 offen offset:3072
    s_mov_b32 s47, 8192
    buffer_load_dwordx4 a[32:35], v14, s[16:19], s47 offen offset:0
    buffer_load_dwordx4 a[36:39], v14, s[16:19], s47 offen offset:1024
    buffer_load_dwordx4 a[40:43], v14, s[16:19], s47 offen offset:2048
    buffer_load_dwordx4 a[44:47], v14, s[16:19], s47 offen offset:3072
    s_mov_b32 s47, 12288
    buffer_load_dwordx4 a[48:51], v14, s[16:19], s47 offen offset:0
    buffer_load_dwordx4 a[52:55], v14, s[16:19], s47 offen offset:1024
    buffer_load_dwordx4 a[56:59], v14, s[16:19], s47 offen offset:2048
    s_branch K1_JOIN
K1_H:
    s_mul_i32 s46, s41, 129024
    s_add_u32 s46, s46, 2359296
    s_lshl_b32 s54, s55, 12
    s_add_u32 s46, s46, s54
    v_add_u32 v5, s46, v1
    s_add_u32 m0, s54, 0
    s_mov_b32 s48, 0
    buffer_load_dwordx4 v5, s[16:19], s48 offen offset:0 lds
    buffer_load_dwordx4 v5, s[16:19], s48 offen offset:1024 lds
    buffer_load_dwordx4 v5, s[16:19], s48 offen offset:2048 lds
    buffer_load_dwordx4 v5, s[16:19], s48 offen offset:3072 lds
    s_add_u32 m0, s54, 16384
    s_mov_b32 s48, 16384
    buffer_load_dwordx4 v5, s[16:19], s48 offen offset:0 lds
    buffer_load_dwordx4 v5, s[16:19], s48 offen offset:1024 lds
    buffer_load_dwordx4 v5, s[16:19], s48 offen offset:2048 lds
    buffer_load_dwordx4 v5, s[16:19], s48 offen offset:3072 lds
    s_add_u32 m0, s54, 32768
    s_mov_b32 s48, 32768
    buffer_load_dwordx4 v5, s[16:19], s48 offen offset:0 lds
    buffer_load_dwordx4 v5, s[16:19], s48 offen offset:1024 lds
    buffer_load_dwordx4 v5, s[16:19], s48 offen offset:2048 lds
    buffer_load_dwordx4 v5, s[16:19], s48 offen offset:3072 lds
    s_mov_b32 s20, s4
    s_mov_b32 s21, s5
    s_mov_b32 s22, 2359296
    s_mov_b32 s23, 0x20000
    s_mov_b32 s24, s14
    s_mov_b32 s25, s15
    s_mov_b32 s26, 2359296
    s_mov_b32 s27, 0x20000
    s_mov_b32 s28, s8
    s_mov_b32 s29, s9
    s_mov_b32 s30, 5308416
    s_mov_b32 s31, 0x20000
    s_mov_b32 s32, s10
    s_mov_b32 s33, s11
    s_mov_b32 s34, 5308416
    s_mov_b32 s35, 0x20000
    s_mov_b32 s36, s12
    s_mov_b32 s37, s13
    s_mov_b32 s38, 5308416
    s_mov_b32 s39, 0x20000
    v_mov_b32 v8, 0
    v_mov_b32 v9, 0
    v_mov_b32 v10, 0
    v_mov_b32 v11, 0
    v_subrev_u32 v12, 256, v4
    v_lshlrev_b32 v13, 4, v12
    v_add_u32 v13, 147456, v13
    ds_write_b128 v13, v[8:11]
    v_cmp_gt_u32 vcc, 176, v12
    s_and_saveexec_b64 s[50:51], vcc
    ds_write_b128 v13, v[8:11] offset:4096
    s_mov_b64 exec, s[50:51]
    s_waitcnt lgkmcnt(0)
    s_waitcnt vmcnt(8)
    s_barrier
    s_add_u32 m0, s54, 49152
    s_mov_b32 s48, 49152
    buffer_load_dwordx4 v5, s[16:19], s48 offen offset:0 lds
    buffer_load_dwordx4 v5, s[16:19], s48 offen offset:1024 lds
    buffer_load_dwordx4 v5, s[16:19], s48 offen offset:2048 lds
    buffer_load_dwordx4 v5, s[16:19], s48 offen offset:3072 lds
    s_mov_b32 s48, s6
    s_mov_b32 s49, s7
    s_mov_b32 s50, 10890496
    s_mov_b32 s51, 0x20000
    s_lshl_b32 s46, s2, 2
    s_add_u32 s46, s46, s55
    s_lshl_b32 s46, s46, 12
    s_add_u32 s46, s46, 6774784
    v_mov_b32 v28, -1
    v_mov_b32 v29, -1
    v_mov_b32 v30, -1
    v_mov_b32 v31, -1
    v_add_u32 v26, s46, v1
    buffer_store_dwordx4 v[28:31], v26, s[48:51], 0 offen offset:0 sc1
    buffer_store_dwordx4 v[28:31], v26, s[48:51], 0 offen offset:1024 sc1
    buffer_store_dwordx4 v[28:31], v26, s[48:51], 0 offen offset:2048 sc1
    buffer_store_dwordx4 v[28:31], v26, s[48:51], 0 offen offset:3072 sc1
    s_lshl_b32 s46, s41, 4
    s_add_u32 s46, s46, s40
    s_mul_i32 s46, s46, 6144
    s_mul_i32 s47, s55, 1536
    s_add_u32 s46, s46, s47
    s_add_u32 s46, s46, 5201920
    v_add_u32 v26, s46, v1
    v_mov_b32 v27, 1073741824
    v_cmp_gt_u32 vcc, 32, v0
    s_nop 1
    v_cndmask_b32 v27, v27, v26, vcc
    buffer_store_dwordx4 v[28:31], v26, s[48:51], 0 offen sc1
    buffer_store_dwordx4 v[28:31], v27, s[48:51], 0 offen offset:1024 sc1
    s_waitcnt vmcnt(14)
    s_barrier
    s_add_u32 m0, s54, 65536
    s_mov_b32 s48, 65536
    buffer_load_dwordx4 v5, s[16:19], s48 offen offset:0 lds
    buffer_load_dwordx4 v5, s[16:19], s48 offen offset:1024 lds
    buffer_load_dwordx4 v5, s[16:19], s48 offen offset:2048 lds
    buffer_load_dwordx4 v5, s[16:19], s48 offen offset:3072 lds
    s_waitcnt vmcnt(14)
    s_barrier
    s_add_u32 m0, s54, 81920
    s_mov_b32 s48, 81920
    buffer_load_dwordx4 v5, s[16:19], s48 offen offset:0 lds
    buffer_load_dwordx4 v5, s[16:19], s48 offen offset:1024 lds
    buffer_load_dwordx4 v5, s[16:19], s48 offen offset:2048 lds
    buffer_load_dwordx4 v5, s[16:19], s48 offen offset:3072 lds
    s_waitcnt vmcnt(14)
    s_barrier
    s_waitcnt vmcnt(4)
    s_barrier
    s_waitcnt vmcnt(0)
    s_barrier
    s_cmp_lg_u32 s3, 7
    s_cbranch_scc1 NOF2_5
    s_lshl_b32 s46, s2, 7
    s_add_u32 s46, s46, 5165120
    v_mov_b32 v26, s46
    v_mov_b32 v27, s63
    s_mov_b64 exec, 1
    buffer_store_dword v27, v26, s[16:19], 0 offen sc1
    s_mov_b64 exec, -1
NOF2_5:
    v_lshrrev_b32 v9, 2, v0
    v_mul_u32_u24 v9, 288, v9
    s_lshr_b32 s46, s55, 1
    s_lshl_b32 s47, s46, 7
    v_add_u32 v9, s47, v9
    v_and_b32 v10, 3, v0
    v_add_u32 v11, 0, v10
    v_lshlrev_b32 v24, 3, v11
    v_add_u32 v13, 24, v24
    v_cmp_gt_u32 vcc, 5, v11
    s_nop 1
    v_cndmask_b32 v24, v13, v24, vcc
    v_add_u32 v14, v9, v24
    v_add_u32 v11, 4, v10
    v_lshlrev_b32 v24, 3, v11
    v_add_u32 v13, 24, v24
    v_cmp_gt_u32 vcc, 5, v11
    s_nop 1
    v_cndmask_b32 v24, v13, v24, vcc
    v_add_u32 v15, v9, v24
    v_add_u32 v11, 8, v10
    v_lshlrev_b32 v24, 3, v11
    v_add_u32 v13, 24, v24
    v_cmp_gt_u32 vcc, 5, v11
    s_nop 1
    v_cndmask_b32 v24, v13, v24, vcc
    v_add_u32 v16, v9, v24
    s_and_b32 s48, s55, 1
    s_lshl_b32 s47, s48, 2
    v_add_u32 v11, s47, v10
    v_lshlrev_b32 v24, 3, v11
    v_add_u32 v13, 80, v24
    v_add_u32 v24, 40, v24
    v_cmp_gt_u32 vcc, 3, v11
    s_nop 1
    v_cndmask_b32 v24, v13, v24, vcc
    v_mov_b32 v13, 40
    v_cmp_gt_u32 vcc, 6, v11
    s_nop 1
    v_cndmask_b32 v24, v13, v24, vcc
    v_add_u32 v17, v9, v24
    s_lshl_b32 s47, s48, 4
    v_add_u32 v11, s47, v2
    v_subrev_u32 v24, 2, v11
    v_cmp_le_u32 vcc, 12, v11
    s_nop 1
    v_cndmask_b32 v24, v11, v24, vcc
    s_mul_i32 s49, s46, 19
    v_add_u32 v24, s49, v24
    v_mul_u32_u24 v24, 10, v24
    v_add_u32 v24, v24, v3
    v_lshlrev_b32 v24, 4, v24
    v_add_u32 v24, 155904, v24
    v_mov_b32 v13, 161984
    v_subrev_u32 v19, 12, v11
    v_cmp_gt_u32 s[52:53], 9, v19
    v_cmp_gt_u32 vcc, 10, v11
    s_or_b64 vcc, vcc, s[52:53]
    s_nop 0
    v_cndmask_b32 v18, v13, v24, vcc
    v_cmp_gt_u32 s[52:53], 2, v3
    s_and_b64 vcc, vcc, s[52:53]
    v_add_u32 v24, 128, v24
    v_cndmask_b32 v19, v13, v24, vcc
    s_mul_i32 s49, s46, 190
    s_mul_i32 s50, s48, 140
    s_add_u32 s49, s49, s50
    s_lshl_b32 s49, s49, 4
    s_add_u32 s50, s49, 155904
    v_add_u32 v37, s50, v1
    s_lshl_b32 s50, s41, 4
    s_add_u32 s50, s50, s40
    s_mul_i32 s50, s50, 6144
    s_add_u32 s50, s50, 5201920
    s_add_u32 s50, s50, s49
    v_add_u32 v24, s50, v1
    s_cmp_eq_u32 s48, 0
    s_cselect_b32 s49, 140, 50
    v_mov_b32 v13, 1073741824
    v_add_u32 v11, 0, v0
    v_cmp_gt_u32 vcc, s49, v11
    s_nop 1
    v_cndmask_b32 v38, v13, v24, vcc
    v_add_u32 v11, 64, v0
    v_cmp_gt_u32 vcc, s49, v11
    s_nop 1
    v_cndmask_b32 v39, v13, v24, vcc
    v_add_u32 v11, 128, v0
    v_cmp_gt_u32 vcc, s49, v11
    s_nop 1
    v_cndmask_b32 v40, v13, v24, vcc
    s_mul_i32 s46, s41, 98304
    s_add_u32 s46, s46, 5201920
    v_mov_b32 v24, v12
    v_mul_u32_u24 v8, 6554, v24
    v_lshrrev_b32 v8, 16, v8
    v_mul_u32_u24 v9, 10, v8
    v_sub_u32 v9, v24, v9
    v_cmp_le_u32 vcc, 19, v8
    s_nop 1
    v_cndmask_b32 v10, 0, 1, vcc
    v_mul_u32_u24 v11, 19, v10
    v_sub_u32 v11, v8, v11
    v_cmp_le_u32 vcc, 10, v11
    s_nop 1
    v_cndmask_b32 v13, 0, 2, vcc
    v_add_u32 v11, v11, v13
    v_mad_u32_u24 v11, v10, 24, v11
    v_lshlrev_b32 v20, 4, v24
    v_add_u32 v20, s46, v20
    v_mul_u32_u24 v21, 96, v11
    v_lshl_add_u32 v21, v9, 3, v21
    v_cmp_le_u32 vcc, 5, v9
    s_nop 1
    v_cndmask_b32 v13, 0, 8, vcc
    v_add_u32 v21, v21, v13
    v_add_u32 v21, 147456, v21
    v_lshrrev_b32 v24, 1, v12
    v_add_u32 v24, 256, v24
    v_min_u32 v24, 379, v24
    v_mul_u32_u24 v8, 6554, v24
    v_lshrrev_b32 v8, 16, v8
    v_mul_u32_u24 v9, 10, v8
    v_sub_u32 v9, v24, v9
    v_cmp_le_u32 vcc, 19, v8
    s_nop 1
    v_cndmask_b32 v10, 0, 1, vcc
    v_mul_u32_u24 v11, 19, v10
    v_sub_u32 v11, v8, v11
    v_cmp_le_u32 vcc, 10, v11
    s_nop 1
    v_cndmask_b32 v13, 0, 2, vcc
    v_add_u32 v11, v11, v13
    v_mad_u32_u24 v11, v10, 24, v11
    v_lshlrev_b32 v22, 4, v24
    v_add_u32 v22, s46, v22
    v_and_b32 v13, 1, v12
    v_mul_u32_u24 v13, 49152, v13
    v_add_u32 v22, v22, v13
    v_mul_u32_u24 v23, 96, v11
    v_lshl_add_u32 v23, v9, 3, v23
    v_cmp_le_u32 vcc, 5, v9
    s_nop 1
    v_cndmask_b32 v13, 0, 8, vcc
    v_add_u32 v23, v23, v13
    v_add_u32 v23, 147456, v23
    s_barrier
    s_add_u32 m0, s54, 98304
    s_mov_b32 s48, 98304
    buffer_load_dwordx4 v5, s[16:19], s48 offen offset:0 lds
    buffer_load_dwordx4 v5, s[16:19], s48 offen offset:1024 lds
    buffer_load_dwordx4 v5, s[16:19], s48 offen offset:2048 lds
    buffer_load_dwordx4 v5, s[16:19], s48 offen offset:3072 lds
    s_add_u32 m0, s54, 114688
    s_mov_b32 s48, 114688
    buffer_load_dwordx4 v5, s[16:19], s48 offen offset:0 lds
    buffer_load_dwordx4 v5, s[16:19], s48 offen offset:1024 lds
    buffer_load_dwordx4 v5, s[16:19], s48 offen offset:2048 lds
    buffer_load_dwordx4 v5, s[16:19], s48 offen offset:3072 lds
    s_lshl_b32 s46, s43, 2
    s_add_u32 s46, s46, s55
    s_mul_i32 s46, s46, 9
    s_add_u32 s46, s46, 0
    s_mul_i32 s46, s46, 5120
    s_add_u32 s46, s46, 4423680
    v_add_u32 v25, s46, v1
    s_mov_b32 s47, 0
    buffer_load_dwordx4 a[0:3], v25, s[16:19], s47 offen offset:0
    buffer_load_dwordx4 a[4:7], v25, s[16:19], s47 offen offset:1024
    buffer_load_dwordx4 a[8:11], v25, s[16:19], s47 offen offset:2048
    buffer_load_dwordx4 a[12:15], v25, s[16:19], s47 offen offset:3072
    s_mov_b32 s47, 4096
    buffer_load_dwordx4 a[16:19], v25, s[16:19], s47 offen offset:0
    buffer_load_dwordx4 a[20:23], v25, s[16:19], s47 offen offset:1024
    buffer_load_dwordx4 a[24:27], v25, s[16:19], s47 offen offset:2048
    buffer_load_dwordx4 a[28:31], v25, s[16:19], s47 offen offset:3072
    s_waitcnt vmcnt(8)
    s_cmp_lg_u32 s3, 7
    s_cbranch_scc1 NOF2P_6
    v_and_b32 v28, 15, v0
    v_bfe_u32 v29, v0, 4, 1
    v_mov_b32 v30, s40
    v_mov_b32 v31, s41
    v_cmp_eq_u32 vcc, 0, v29
    s_nop 1
    v_cndmask_b32 v30, v28, v30, vcc
    v_cndmask_b32 v31, v31, v28, vcc
    v_and_b32 v32, 3, v30
    v_lshlrev_b32 v32, 3, v32
    v_and_b32 v33, 7, v31
    v_or_b32 v32, v32, v33
    v_lshlrev_b32 v32, 3, v32
    v_lshrrev_b32 v33, 2, v30
    v_lshl_or_b32 v32, v33, 1, v32
    v_lshrrev_b32 v33, 3, v31
    v_or_b32 v32, v32, v33
    v_lshlrev_b32 v32, 7, v32
    v_add_u32 v32, 5165120, v32
    s_mov_b32 s62, 3000
POLL_7:
    buffer_load_dword v33, v32, s[16:19], 0 offen sc1
    s_waitcnt vmcnt(0)
    v_cmp_ne_u32 vcc, s63, v33
    s_cbranch_vccz PDONE_8
    s_sub_u32 s62, s62, 1
    s_cbranch_scc1 PDONE_8
    s_sleep 1
    s_branch POLL_7
PDONE_8:
NOF2P_6:
    s_barrier
    ds_read_b64_tr_b16 v[92:93], v17 offset:0
    ds_read_b64_tr_b16 v[94:95], v17 offset:4608
    ds_read_b64_tr_b16 v[44:45], v14 offset:0
    ds_read_b64_tr_b16 v[46:47], v14 offset:4608
    ds_read_b64_tr_b16 v[48:49], v15 offset:0
    ds_read_b64_tr_b16 v[50:51], v15 offset:4608
    ds_read_b64_tr_b16 v[52:53], v16 offset:0
    ds_read_b64_tr_b16 v[54:55], v16 offset:4608
    ds_read_b64_tr_b16 v[96:97], v17 offset:9216
    ds_read_b64_tr_b16 v[98:99], v17 offset:13824
    ds_read_b64_tr_b16 v[56:57], v14 offset:9216
    ds_read_b64_tr_b16 v[58:59], v14 offset:13824
    s_waitcnt lgkmcnt(4)
    v_mfma_f32_16x16x32_bf16 v[24:27], v[44:47], v[92:95], 0
    v_mfma_f32_16x16x32_bf16 v[28:31], v[48:51], v[92:95], 0
    v_mfma_f32_16x16x32_bf16 v[32:35], v[52:55], v[92:95], 0
    ds_read_b64_tr_b16 v[60:61], v15 offset:9216
    ds_read_b64_tr_b16 v[62:63], v15 offset:13824
    ds_read_b64_tr_b16 v[64:65], v16 offset:9216
    ds_read_b64_tr_b16 v[66:67], v16 offset:13824
    ds_read_b64_tr_b16 v[100:101], v17 offset:18432
    ds_read_b64_tr_b16 v[102:103], v17 offset:23040
    ds_read_b64_tr_b16 v[68:69], v14 offset:18432
    ds_read_b64_tr_b16 v[70:71], v14 offset:23040
    s_waitcnt lgkmcnt(4)
    v_mfma_f32_16x16x32_bf16 v[24:27], v[56:59], v[96:99], v[24:27]
    v_mfma_f32_16x16x32_bf16 v[28:31], v[60:63], v[96:99], v[28:31]
    v_mfma_f32_16x16x32_bf16 v[32:35], v[64:67], v[96:99], v[32:35]
    ds_read_b64_tr_b16 v[72:73], v15 offset:18432
    ds_read_b64_tr_b16 v[74:75], v15 offset:23040
    ds_read_b64_tr_b16 v[76:77], v16 offset:18432
    ds_read_b64_tr_b16 v[78:79], v16 offset:23040
    ds_read_b64_tr_b16 v[104:105], v17 offset:27648
    ds_read_b64_tr_b16 v[106:107], v17 offset:32256
    ds_read_b64_tr_b16 v[80:81], v14 offset:27648
    ds_read_b64_tr_b16 v[82:83], v14 offset:32256
    s_waitcnt lgkmcnt(4)
    v_mfma_f32_16x16x32_bf16 v[24:27], v[68:71], v[100:103], v[24:27]
    v_mfma_f32_16x16x32_bf16 v[28:31], v[72:75], v[100:103], v[28:31]
    v_mfma_f32_16x16x32_bf16 v[32:35], v[76:79], v[100:103], v[32:35]
    ds_read_b64_tr_b16 v[84:85], v15 offset:27648
    ds_read_b64_tr_b16 v[86:87], v15 offset:32256
    ds_read_b64_tr_b16 v[88:89], v16 offset:27648
    ds_read_b64_tr_b16 v[90:91], v16 offset:32256
    s_waitcnt lgkmcnt(0)
    v_mfma_f32_16x16x32_bf16 v[24:27], v[80:83], v[104:107], v[24:27]
    v_mfma_f32_16x16x32_bf16 v[28:31], v[84:87], v[104:107], v[28:31]
    v_mfma_f32_16x16x32_bf16 v[32:35], v[88:91], v[104:107], v[32:35]
    s_nop 5
    ds_write_b128 v18, v[24:27] offset:0
    ds_write_b128 v18, v[28:31] offset:64
    ds_write_b128 v19, v[32:35] offset:0
    s_waitcnt lgkmcnt(0)
    ds_read_b128 v[24:27], v37 offset:0
    ds_read_b128 v[28:31], v37 offset:1024
    ds_read_b128 v[32:35], v37 offset:2048
    s_waitcnt lgkmcnt(2)
    buffer_store_dwordx4 v[24:27], v38, s[16:19], 0 offen offset:0 sc1
    s_waitcnt lgkmcnt(1)
    buffer_store_dwordx4 v[28:31], v39, s[16:19], 0 offen offset:1024 sc1
    s_waitcnt lgkmcnt(0)
    buffer_store_dwordx4 v[32:35], v40, s[16:19], 0 offen offset:2048 sc1
    s_lshl_b32 s46, s43, 2
    s_add_u32 s46, s46, s55
    s_mul_i32 s46, s46, 9
    s_add_u32 s46, s46, 0
    s_mul_i32 s46, s46, 5120
    s_add_u32 s46, s46, 4423680
    v_add_u32 v42, s46, v1
    s_mov_b32 s47, 8192
    buffer_load_dwordx4 a[32:35], v42, s[16:19], s47 offen offset:0
    buffer_load_dwordx4 a[36:39], v42, s[16:19], s47 offen offset:1024
    buffer_load_dwordx4 a[40:43], v42, s[16:19], s47 offen offset:2048
    buffer_load_dwordx4 a[44:47], v42, s[16:19], s47 offen offset:3072
    s_mov_b32 s47, 12288
    buffer_load_dwordx4 a[48:51], v42, s[16:19], s47 offen offset:0
    buffer_load_dwordx4 a[52:55], v42, s[16:19], s47 offen offset:1024
    buffer_load_dwordx4 a[56:59], v42, s[16:19], s47 offen offset:2048
    buffer_load_dwordx4 a[60:63], v42, s[16:19], s47 offen offset:3072
    s_mov_b32 s47, 16384
    buffer_load_dwordx4 a[64:67], v42, s[16:19], s47 offen offset:0
    buffer_load_dwordx4 a[68:71], v42, s[16:19], s47 offen offset:1024
    buffer_load_dwordx4 a[72:75], v42, s[16:19], s47 offen offset:2048
    buffer_load_dwordx4 a[76:79], v42, s[16:19], s47 offen offset:3072
    s_mov_b32 s47, 20480
    buffer_load_dwordx4 a[80:83], v42, s[16:19], s47 offen offset:0
    buffer_load_dwordx4 a[84:87], v42, s[16:19], s47 offen offset:1024
    buffer_load_dwordx4 a[88:91], v42, s[16:19], s47 offen offset:2048
    buffer_load_dwordx4 a[92:95], v42, s[16:19], s47 offen offset:3072
    s_mov_b32 s47, 24576
    buffer_load_dwordx4 a[96:99], v42, s[16:19], s47 offen offset:0
    buffer_load_dwordx4 a[100:103], v42, s[16:19], s47 offen offset:1024
    buffer_load_dwordx4 a[104:107], v42, s[16:19], s47 offen offset:2048
    buffer_load_dwordx4 a[108:111], v42, s[16:19], s47 offen offset:3072
    s_mov_b32 s47, 28672
    buffer_load_dwordx4 a[112:115], v42, s[16:19], s47 offen offset:0
    buffer_load_dwordx4 a[116:119], v42, s[16:19], s47 offen offset:1024
    s_mov_b32 s62, 3000
POLL_9:
    s_mov_b32 s46, 0
    buffer_load_dwordx4 v[32:35], v20, s[16:19], s46 offen sc1
    s_mov_b32 s47, 6144
    buffer_load_dwordx4 v[36:39], v20, s[16:19], s47 offen sc1
    s_mov_b32 s46, 12288
    buffer_load_dwordx4 v[40:43], v20, s[16:19], s46 offen sc1
    s_mov_b32 s47, 18432
    buffer_load_dwordx4 v[44:47], v20, s[16:19], s47 offen sc1
    s_mov_b32 s46, 24576
    buffer_load_dwordx4 v[48:51], v20, s[16:19], s46 offen sc1
    s_mov_b32 s47, 30720
    buffer_load_dwordx4 v[52:55], v20, s[16:19], s47 offen sc1
    s_mov_b32 s46, 36864
    buffer_load_dwordx4 v[56:59], v20, s[16:19], s46 offen sc1
    s_mov_b32 s47, 43008
    buffer_load_dwordx4 v[60:63], v20, s[16:19], s47 offen sc1
    s_mov_b32 s46, 49152
    buffer_load_dwordx4 v[64:67], v20, s[16:19], s46 offen sc1
    s_mov_b32 s47, 55296
    buffer_load_dwordx4 v[68:71], v20, s[16:19], s47 offen sc1
    s_mov_b32 s46, 61440
    buffer_load_dwordx4 v[72:75], v20, s[16:19], s46 offen sc1
    s_mov_b32 s47, 67584
    buffer_load_dwordx4 v[76:79], v20, s[16:19], s47 offen sc1
    s_mov_b32 s46, 73728
    buffer_load_dwordx4 v[80:83], v20, s[16:19], s46 offen sc1
    s_mov_b32 s47, 79872
    buffer_load_dwordx4 v[84:87], v20, s[16:19], s47 offen sc1
    s_mov_b32 s46, 86016
    buffer_load_dwordx4 v[88:91], v20, s[16:19], s46 offen sc1
    s_mov_b32 s47, 92160
    buffer_load_dwordx4 v[92:95], v20, s[16:19], s47 offen sc1
    s_mov_b32 s46, 0
    buffer_load_dwordx4 v[96:99], v22, s[16:19], s46 offen sc1
    s_mov_b32 s47, 6144
    buffer_load_dwordx4 v[100:103], v22, s[16:19], s47 offen sc1
    s_mov_b32 s46, 12288
    buffer_load_dwordx4 v[104:107], v22, s[16:19], s46 offen sc1
    s_mov_b32 s47, 18432
    buffer_load_dwordx4 v[108:111], v22, s[16:19], s47 offen sc1
    s_mov_b32 s46, 24576
    buffer_load_dwordx4 v[28:31], v22, s[16:19], s46 offen sc1
    s_mov_b32 s47, 30720
    buffer_load_dwordx4 v[8:11], v22, s[16:19], s47 offen sc1
    s_mov_b32 s46, 36864
    buffer_load_dwordx4 v[14:17], v22, s[16:19], s46 offen sc1
    s_mov_b32 s47, 43008
    buffer_load_dwordx4 v[24:27], v22, s[16:19], s47 offen sc1
    s_waitcnt vmcnt(0)
    v_pk_add_f32 v[32:33], v[32:33], v[36:37]
    v_pk_add_f32 v[34:35], v[34:35], v[38:39]
    v_pk_add_f32 v[40:41], v[40:41], v[44:45]
    v_pk_add_f32 v[42:43], v[42:43], v[46:47]
    v_pk_add_f32 v[48:49], v[48:49], v[52:53]
    v_pk_add_f32 v[50:51], v[50:51], v[54:55]
    v_pk_add_f32 v[56:57], v[56:57], v[60:61]
    v_pk_add_f32 v[58:59], v[58:59], v[62:63]
    v_pk_add_f32 v[64:65], v[64:65], v[68:69]
    v_pk_add_f32 v[66:67], v[66:67], v[70:71]
    v_pk_add_f32 v[72:73], v[72:73], v[76:77]
    v_pk_add_f32 v[74:75], v[74:75], v[78:79]
    v_pk_add_f32 v[80:81], v[80:81], v[84:85]
    v_pk_add_f32 v[82:83], v[82:83], v[86:87]
    v_pk_add_f32 v[88:89], v[88:89], v[92:93]
    v_pk_add_f32 v[90:91], v[90:91], v[94:95]
    v_pk_add_f32 v[32:33], v[32:33], v[40:41]
    v_pk_add_f32 v[34:35], v[34:35], v[42:43]
    v_pk_add_f32 v[48:49], v[48:49], v[56:57]
    v_pk_add_f32 v[50:51], v[50:51], v[58:59]
    v_pk_add_f32 v[64:65], v[64:65], v[72:73]
    v_pk_add_f32 v[66:67], v[66:67], v[74:75]
    v_pk_add_f32 v[80:81], v[80:81], v[88:89]
    v_pk_add_f32 v[82:83], v[82:83], v[90:91]
    v_pk_add_f32 v[32:33], v[32:33], v[48:49]
    v_pk_add_f32 v[34:35], v[34:35], v[50:51]
    v_pk_add_f32 v[64:65], v[64:65], v[80:81]
    v_pk_add_f32 v[66:67], v[66:67], v[82:83]
    v_pk_add_f32 v[32:33], v[32:33], v[64:65]
    v_pk_add_f32 v[34:35], v[34:35], v[66:67]
    v_pk_add_f32 v[96:97], v[96:97], v[100:101]
    v_pk_add_f32 v[98:99], v[98:99], v[102:103]
    v_pk_add_f32 v[104:105], v[104:105], v[108:109]
    v_pk_add_f32 v[106:107], v[106:107], v[110:111]
    v_pk_add_f32 v[28:29], v[28:29], v[8:9]
    v_pk_add_f32 v[30:31], v[30:31], v[10:11]
    v_pk_add_f32 v[14:15], v[14:15], v[24:25]
    v_pk_add_f32 v[16:17], v[16:17], v[26:27]
    v_pk_add_f32 v[96:97], v[96:97], v[104:105]
    v_pk_add_f32 v[98:99], v[98:99], v[106:107]
    v_pk_add_f32 v[28:29], v[28:29], v[14:15]
    v_pk_add_f32 v[30:31], v[30:31], v[16:17]
    v_pk_add_f32 v[96:97], v[96:97], v[28:29]
    v_pk_add_f32 v[98:99], v[98:99], v[30:31]
    s_nop 0
    v_add_f32_dpp v96, v96, v96 quad_perm:[1,0,3,2] row_mask:0xf bank_mask:0xf
    v_add_f32_dpp v97, v97, v97 quad_perm:[1,0,3,2] row_mask:0xf bank_mask:0xf
    v_add_f32_dpp v98, v98, v98 quad_perm:[1,0,3,2] row_mask:0xf bank_mask:0xf
    v_add_f32_dpp v99, v99, v99 quad_perm:[1,0,3,2] row_mask:0xf bank_mask:0xf
    v_add_f32 v18, v32, v33
    v_add_f32 v19, v34, v35
    v_add_f32 v18, v18, v19
    v_add_f32 v19, v96, v97
    v_add_f32 v18, v18, v19
    v_add_f32 v19, v98, v99
    v_add_f32 v18, v18, v19
    v_cmp_u_f32 vcc, v18, v18
    s_cbranch_vccz PDONE_10
    s_sub_u32 s62, s62, 1
    s_cbranch_scc1 PDONE_10
    s_sleep 1
    s_branch POLL_9
PDONE_10:
    v_cvt_pk_bf16_f32 v18, v32, v33
    v_cvt_pk_bf16_f32 v19, v34, v35
    ds_write_b64 v21, v[18:19]
    v_cvt_pk_bf16_f32 v26, v96, v97
    v_cvt_pk_bf16_f32 v27, v98, v99
    v_cmp_gt_u32 vcc, 248, v12
    s_and_saveexec_b64 s[50:51], vcc
    ds_write_b64 v23, v[26:27]
    s_mov_b64 exec, s[50:51]
    s_waitcnt lgkmcnt(0)
    s_barrier
    s_cmp_lg_u32 s2, 0
    s_cbranch_scc1 NOEP_11
    s_cmp_lg_u32 s3, 7
    s_cbranch_scc1 NOEP_11
    v_mov_b32 v8, 5197824
    v_mov_b32 v9, s63
    s_mov_b64 exec, 1
    buffer_store_dword v9, v8, s[16:19], 0 offen sc1
    s_mov_b64 exec, -1
NOEP_11:
K1_JOIN:
    s_nop 7
    s_lshr_b32 s46, s45, 2
    s_sub_u32 s47, s45, s46
    s_sub_u32 s47, s47, 1
    s_mul_i32 s61, s44, 18
    s_add_u32 s61, s61, s47
    s_cmp_lt_u32 s47, 18
    s_cselect_b32 s61, s61, -1
    s_cmp_eq_u32 s43, 0
    s_cselect_b32 s61, -1, s61
    s_sub_u32 s48, s47, 10
    s_cmp_eq_u32 s43, 0
    s_cselect_b32 s48, s46, s48
    s_mul_i32 s54, s44, 14
    s_add_u32 s54, s54, s48
    s_lshl_b32 s48, s44, 2
    s_add_u32 s48, s48, s47
    s_add_u32 s48, s48, 112
    s_cmp_lt_u32 s47, 4
    s_cselect_b32 s48, s48, -1
    s_cmp_lt_u32 s61, 144
    s_cselect_b32 s54, s48, s54
    s_and_b32 s56, s3, 1
    s_lshr_b32 s57, s3, 1
    s_lshl_b32 s58, s57, 1
    s_add_u32 s58, s58, 1
    s_cmp_eq_u32 s57, 0
    s_cselect_b32 s58, 0, s58
    s_mul_i32 s59, s43, 144
    s_lshl_b32 s46, s58, 4
    s_add_u32 s59, s59, s46
    s_lshl_b32 s46, s42, 5
    s_lshl_b32 s47, s56, 4
    s_add_u32 s46, s46, s47
    v_add_u32 v5, s46, v2
    v_mul_u32_u24 v6, 1152, v5
    v_lshlrev_b32 v7, 2, v3
    v_add_u32 v7, s59, v7
    v_lshl_add_u32 v6, v7, 1, v6
    v_lshlrev_b32 v8, 2, v7
    v_add_u32 v8, 5160960, v8
    buffer_load_dwordx2 a[120:121], v6, s[20:23], 0 offen offset:0
    buffer_load_dwordx4 a[128:131], v8, s[16:19], 0 offen offset:0
    buffer_load_dwordx2 a[122:123], v6, s[20:23], 0 offen offset:32
    buffer_load_dwordx4 a[132:135], v8, s[16:19], 0 offen offset:64
    buffer_load_dwordx2 a[124:125], v6, s[20:23], 0 offen offset:64
    buffer_load_dwordx4 a[136:139], v8, s[16:19], 0 offen offset:128
    s_lshl_b32 s46, s42, 5
    s_lshl_b32 s47, s55, 2
    s_add_u32 s46, s46, s47
    s_lshl_b32 s47, s46, 10
    s_add_u32 s47, s47, 6774784
    v_add_u32 v9, s47, v1
    s_lshl_b32 s47, s46, 8
    s_add_u32 s47, s47, 8871936
    v_lshlrev_b32 v10, 2, v0
    v_add_u32 v10, s47, v10
    s_mov_b32 s62, 3000
POLL_12:
    s_mov_b32 s46, 16384
    s_mov_b32 s47, 4096
    buffer_load_dwordx4 v[12:15], v9, s[16:19], 0 offen offset:0 sc1
    buffer_load_dwordx4 v[16:19], v9, s[16:19], 0 offen offset:1024 sc1
    buffer_load_dwordx4 v[20:23], v9, s[16:19], 0 offen offset:2048 sc1
    buffer_load_dwordx4 v[24:27], v9, s[16:19], 0 offen offset:3072 sc1
    buffer_load_dword v28, v10, s[16:19], 0 offen offset:0 sc1
    buffer_load_dword v29, v10, s[16:19], 0 offen offset:256 sc1
    buffer_load_dword v30, v10, s[16:19], 0 offen offset:512 sc1
    buffer_load_dword v31, v10, s[16:19], 0 offen offset:768 sc1
    buffer_load_dwordx4 v[32:35], v9, s[16:19], s46 offen offset:0 sc1
    buffer_load_dwordx4 v[36:39], v9, s[16:19], s46 offen offset:1024 sc1
    buffer_load_dwordx4 v[40:43], v9, s[16:19], s46 offen offset:2048 sc1
    buffer_load_dwordx4 v[44:47], v9, s[16:19], s46 offen offset:3072 sc1
    buffer_load_dword v48, v10, s[16:19], s47 offen offset:0 sc1
    buffer_load_dword v49, v10, s[16:19], s47 offen offset:256 sc1
    buffer_load_dword v50, v10, s[16:19], s47 offen offset:512 sc1
    buffer_load_dword v51, v10, s[16:19], s47 offen offset:768 sc1
    s_waitcnt vmcnt(0)
    v_max3_u32 v11, v12, v13, v14
    v_max3_u32 v11, v11, v15, v16
    v_max3_u32 v11, v11, v17, v18
    v_max3_u32 v11, v11, v19, v20
    v_max3_u32 v11, v11, v21, v22
    v_max3_u32 v11, v11, v23, v24
    v_max3_u32 v11, v11, v25, v26
    v_max3_u32 v11, v11, v27, v28
    v_max3_u32 v11, v11, v29, v30
    v_max3_u32 v11, v11, v31, v32
    v_max3_u32 v11, v11, v33, v34
    v_max3_u32 v11, v11, v35, v36
    v_max3_u32 v11, v11, v37, v38
    v_max3_u32 v11, v11, v39, v40
    v_max3_u32 v11, v11, v41, v42
    v_max3_u32 v11, v11, v43, v44
    v_max3_u32 v11, v11, v45, v46
    v_max3_u32 v11, v11, v47, v48
    v_max3_u32 v11, v11, v49, v50
    v_max_u32 v11, v11, v51
    v_cmp_eq_u32 vcc, -1, v11
    s_cbranch_vccz PDONE_13
    s_sub_u32 s62, s62, 1
    s_cbranch_scc1 PDONE_13
    s_sleep 1
    s_branch POLL_12
PDONE_13:
    s_mul_i32 s46, s55, 18432
    v_add_u32 v11, s46, v1
    s_cmp_lt_u32 s3, 4
    s_cbranch_scc1 S3C_14
    v_mfma_f32_16x16x32_bf16 v[52:55], a[0:3], v[12:15], 0
    v_mfma_f32_16x16x32_bf16 v[56:59], a[0:3], v[32:35], 0
    v_mfma_f32_16x16x32_bf16 v[60:63], a[20:23], v[12:15], 0
    v_mfma_f32_16x16x32_bf16 v[64:67], a[20:23], v[32:35], 0
    v_mfma_f32_16x16x32_bf16 v[68:71], a[40:43], v[12:15], 0
    v_mfma_f32_16x16x32_bf16 v[72:75], a[40:43], v[32:35], 0
    v_mfma_f32_16x16x32_bf16 v[76:79], a[60:63], v[12:15], 0
    v_mfma_f32_16x16x32_bf16 v[80:83], a[60:63], v[32:35], 0
    v_mfma_f32_16x16x32_bf16 v[84:87], a[80:83], v[12:15], 0
    v_mfma_f32_16x16x32_bf16 v[88:91], a[80:83], v[32:35], 0
    v_mfma_f32_16x16x32_bf16 v[92:95], a[100:103], v[12:15], 0
    v_mfma_f32_16x16x32_bf16 v[96:99], a[100:103], v[32:35], 0
    v_mfma_f32_16x16x32_bf16 v[52:55], a[4:7], v[16:19], v[52:55]
    v_mfma_f32_16x16x32_bf16 v[56:59], a[4:7], v[36:39], v[56:59]
    v_mfma_f32_16x16x32_bf16 v[60:63], a[24:27], v[16:19], v[60:63]
    v_mfma_f32_16x16x32_bf16 v[64:67], a[24:27], v[36:39], v[64:67]
    v_mfma_f32_16x16x32_bf16 v[68:71], a[44:47], v[16:19], v[68:71]
    v_mfma_f32_16x16x32_bf16 v[72:75], a[44:47], v[36:39], v[72:75]
    v_mfma_f32_16x16x32_bf16 v[76:79], a[64:67], v[16:19], v[76:79]
    v_mfma_f32_16x16x32_bf16 v[80:83], a[64:67], v[36:39], v[80:83]
    v_mfma_f32_16x16x32_bf16 v[84:87], a[84:87], v[16:19], v[84:87]
    v_mfma_f32_16x16x32_bf16 v[88:91], a[84:87], v[36:39], v[88:91]
    v_mfma_f32_16x16x32_bf16 v[92:95], a[104:107], v[16:19], v[92:95]
    v_mfma_f32_16x16x32_bf16 v[96:99], a[104:107], v[36:39], v[96:99]
    v_mfma_f32_16x16x32_bf16 v[52:55], a[8:11], v[20:23], v[52:55]
    v_mfma_f32_16x16x32_bf16 v[56:59], a[8:11], v[40:43], v[56:59]
    v_mfma_f32_16x16x32_bf16 v[60:63], a[28:31], v[20:23], v[60:63]
    v_mfma_f32_16x16x32_bf16 v[64:67], a[28:31], v[40:43], v[64:67]
    v_mfma_f32_16x16x32_bf16 v[68:71], a[48:51], v[20:23], v[68:71]
    v_mfma_f32_16x16x32_bf16 v[72:75], a[48:51], v[40:43], v[72:75]
    v_mfma_f32_16x16x32_bf16 v[76:79], a[68:71], v[20:23], v[76:79]
    v_mfma_f32_16x16x32_bf16 v[80:83], a[68:71], v[40:43], v[80:83]
    v_mfma_f32_16x16x32_bf16 v[84:87], a[88:91], v[20:23], v[84:87]
    v_mfma_f32_16x16x32_bf16 v[88:91], a[88:91], v[40:43], v[88:91]
    v_mfma_f32_16x16x32_bf16 v[92:95], a[108:111], v[20:23], v[92:95]
    v_mfma_f32_16x16x32_bf16 v[96:99], a[108:111], v[40:43], v[96:99]
    v_mfma_f32_16x16x32_bf16 v[52:55], a[12:15], v[24:27], v[52:55]
    v_mfma_f32_16x16x32_bf16 v[56:59], a[12:15], v[44:47], v[56:59]
    v_mfma_f32_16x16x32_bf16 v[60:63], a[32:35], v[24:27], v[60:63]
    v_mfma_f32_16x16x32_bf16 v[64:67], a[32:35], v[44:47], v[64:67]
    v_mfma_f32_16x16x32_bf16 v[68:71], a[52:55], v[24:27], v[68:71]
    v_mfma_f32_16x16x32_bf16 v[72:75], a[52:55], v[44:47], v[72:75]
    v_mfma_f32_16x16x32_bf16 v[76:79], a[72:75], v[24:27], v[76:79]
    v_mfma_f32_16x16x32_bf16 v[80:83], a[72:75], v[44:47], v[80:83]
    v_mfma_f32_16x16x32_bf16 v[84:87], a[92:95], v[24:27], v[84:87]
    v_mfma_f32_16x16x32_bf16 v[88:91], a[92:95], v[44:47], v[88:91]
    v_mfma_f32_16x16x32_bf16 v[92:95], a[112:115], v[24:27], v[92:95]
    v_mfma_f32_16x16x32_bf16 v[96:99], a[112:115], v[44:47], v[96:99]
    v_mfma_f32_16x16x32_bf16 v[52:55], a[16:19], v[28:31], v[52:55]
    v_mfma_f32_16x16x32_bf16 v[56:59], a[16:19], v[48:51], v[56:59]
    v_mfma_f32_16x16x32_bf16 v[60:63], a[36:39], v[28:31], v[60:63]
    v_mfma_f32_16x16x32_bf16 v[64:67], a[36:39], v[48:51], v[64:67]
    v_mfma_f32_16x16x32_bf16 v[68:71], a[56:59], v[28:31], v[68:71]
    v_mfma_f32_16x16x32_bf16 v[72:75], a[56:59], v[48:51], v[72:75]
    v_mfma_f32_16x16x32_bf16 v[76:79], a[76:79], v[28:31], v[76:79]
    v_mfma_f32_16x16x32_bf16 v[80:83], a[76:79], v[48:51], v[80:83]
    v_mfma_f32_16x16x32_bf16 v[84:87], a[96:99], v[28:31], v[84:87]
    v_mfma_f32_16x16x32_bf16 v[88:91], a[96:99], v[48:51], v[88:91]
    v_mfma_f32_16x16x32_bf16 v[92:95], a[116:119], v[28:31], v[92:95]
    v_mfma_f32_16x16x32_bf16 v[96:99], a[116:119], v[48:51], v[96:99]
    ds_write_b128 v11, v[52:55] offset:0
    ds_write_b128 v11, v[56:59] offset:1024
    ds_write_b128 v11, v[60:63] offset:2048
    ds_write_b128 v11, v[64:67] offset:3072
    ds_write_b128 v11, v[68:71] offset:4096
    ds_write_b128 v11, v[72:75] offset:5120
    ds_write_b128 v11, v[76:79] offset:6144
    ds_write_b128 v11, v[80:83] offset:7168
    ds_write_b128 v11, v[84:87] offset:8192
    ds_write_b128 v11, v[88:91] offset:9216
    ds_write_b128 v11, v[92:95] offset:10240
    ds_write_b128 v11, v[96:99] offset:11264
    s_waitcnt lgkmcnt(0)
    s_branch S3J_15
S3C_14:
    v_mfma_f32_16x16x32_bf16 v[52:55], a[0:3], v[12:15], 0
    v_mfma_f32_16x16x32_bf16 v[56:59], a[0:3], v[32:35], 0
    v_mfma_f32_16x16x32_bf16 v[60:63], a[20:23], v[12:15], 0
    v_mfma_f32_16x16x32_bf16 v[64:67], a[20:23], v[32:35], 0
    v_mfma_f32_16x16x32_bf16 v[68:71], a[40:43], v[12:15], 0
    v_mfma_f32_16x16x32_bf16 v[72:75], a[40:43], v[32:35], 0
    v_mfma_f32_16x16x32_bf16 v[52:55], a[4:7], v[16:19], v[52:55]
    v_mfma_f32_16x16x32_bf16 v[56:59], a[4:7], v[36:39], v[56:59]
    v_mfma_f32_16x16x32_bf16 v[60:63], a[24:27], v[16:19], v[60:63]
    v_mfma_f32_16x16x32_bf16 v[64:67], a[24:27], v[36:39], v[64:67]
    v_mfma_f32_16x16x32_bf16 v[68:71], a[44:47], v[16:19], v[68:71]
    v_mfma_f32_16x16x32_bf16 v[72:75], a[44:47], v[36:39], v[72:75]
    v_mfma_f32_16x16x32_bf16 v[52:55], a[8:11], v[20:23], v[52:55]
    v_mfma_f32_16x16x32_bf16 v[56:59], a[8:11], v[40:43], v[56:59]
    v_mfma_f32_16x16x32_bf16 v[60:63], a[28:31], v[20:23], v[60:63]
    v_mfma_f32_16x16x32_bf16 v[64:67], a[28:31], v[40:43], v[64:67]
    v_mfma_f32_16x16x32_bf16 v[68:71], a[48:51], v[20:23], v[68:71]
    v_mfma_f32_16x16x32_bf16 v[72:75], a[48:51], v[40:43], v[72:75]
    v_mfma_f32_16x16x32_bf16 v[52:55], a[12:15], v[24:27], v[52:55]
    v_mfma_f32_16x16x32_bf16 v[56:59], a[12:15], v[44:47], v[56:59]
    v_mfma_f32_16x16x32_bf16 v[60:63], a[32:35], v[24:27], v[60:63]
    v_mfma_f32_16x16x32_bf16 v[64:67], a[32:35], v[44:47], v[64:67]
    v_mfma_f32_16x16x32_bf16 v[68:71], a[52:55], v[24:27], v[68:71]
    v_mfma_f32_16x16x32_bf16 v[72:75], a[52:55], v[44:47], v[72:75]
    v_mfma_f32_16x16x32_bf16 v[52:55], a[16:19], v[28:31], v[52:55]
    v_mfma_f32_16x16x32_bf16 v[56:59], a[16:19], v[48:51], v[56:59]
    v_mfma_f32_16x16x32_bf16 v[60:63], a[36:39], v[28:31], v[60:63]
    v_mfma_f32_16x16x32_bf16 v[64:67], a[36:39], v[48:51], v[64:67]
    v_mfma_f32_16x16x32_bf16 v[68:71], a[56:59], v[28:31], v[68:71]
    v_mfma_f32_16x16x32_bf16 v[72:75], a[56:59], v[48:51], v[72:75]
    s_nop 2
    ds_write_b128 v11, v[52:55] offset:12288
    ds_write_b128 v11, v[56:59] offset:13312
    ds_write_b128 v11, v[60:63] offset:14336
    ds_write_b128 v11, v[64:67] offset:15360
    ds_write_b128 v11, v[68:71] offset:16384
    ds_write_b128 v11, v[72:75] offset:17408
    s_waitcnt lgkmcnt(0)
S3J_15:
    s_nop 1
    s_cmp_lt_u32 s3, 4
    s_cbranch_scc1 NOGU_16
    s_cmp_ge_u32 s61, 144
    s_cbranch_scc1 NOGU_16
    v_lshrrev_b32 v9, 2, v0
    v_mul_u32_u24 v9, 9216, v9
    v_and_b32 v10, 3, v0
    v_lshl_add_u32 v9, v10, 4, v9
    s_lshl_b32 s46, s61, 6
    v_add_u32 v9, s46, v9
    s_lshr_b32 s46, s55, 1
    s_and_b32 s47, s55, 1
    s_mul_i32 s48, s46, 36864
    s_mul_i32 s49, s47, 18432
    s_add_u32 s48, s48, s49
    s_add_u32 s48, s48, 73728
    s_mul_i32 s49, s47, 2654208
    s_cmp_eq_u32 s46, 1
    s_cbranch_scc1 GUUP_17
    s_add_u32 m0, s48, 0
    s_add_u32 s50, s49, 0
    buffer_load_dwordx4 v9, s[28:31], s50 offen nt lds
    s_add_u32 m0, s48, 1024
    s_add_u32 s50, s49, 147456
    buffer_load_dwordx4 v9, s[28:31], s50 offen nt lds
    s_add_u32 m0, s48, 2048
    s_add_u32 s50, s49, 294912
    buffer_load_dwordx4 v9, s[28:31], s50 offen nt lds
    s_add_u32 m0, s48, 3072
    s_add_u32 s50, s49, 442368
    buffer_load_dwordx4 v9, s[28:31], s50 offen nt lds
    s_add_u32 m0, s48, 4096
    s_add_u32 s50, s49, 589824
    buffer_load_dwordx4 v9, s[28:31], s50 offen nt lds
    s_add_u32 m0, s48, 5120
    s_add_u32 s50, s49, 737280
    buffer_load_dwordx4 v9, s[28:31], s50 offen nt lds
    s_branch GUDONE_18
GUUP_17:
    s_add_u32 m0, s48, 0
    s_add_u32 s50, s49, 0
    buffer_load_dwordx4 v9, s[32:35], s50 offen nt lds
    s_add_u32 m0, s48, 1024
    s_add_u32 s50, s49, 147456
    buffer_load_dwordx4 v9, s[32:35], s50 offen nt lds
    s_add_u32 m0, s48, 2048
    s_add_u32 s50, s49, 294912
    buffer_load_dwordx4 v9, s[32:35], s50 offen nt lds
    s_add_u32 m0, s48, 3072
    s_add_u32 s50, s49, 442368
    buffer_load_dwordx4 v9, s[32:35], s50 offen nt lds
    s_add_u32 m0, s48, 4096
    s_add_u32 s50, s49, 589824
    buffer_load_dwordx4 v9, s[32:35], s50 offen nt lds
    s_add_u32 m0, s48, 5120
    s_add_u32 s50, s49, 737280
    buffer_load_dwordx4 v9, s[32:35], s50 offen nt lds
GUDONE_18:
NOGU_16:
    s_barrier
    s_lshl_b32 s46, s58, 1
    s_add_u32 s46, s46, s56
    s_lshl_b32 s46, s46, 10
    v_add_u32 v11, s46, v1
    v_mov_b32 v72, 0
    v_mov_b32 v73, 0
    v_mov_b32 v74, 0
    v_mov_b32 v75, 0
    ds_read_b128 v[12:15], v11 offset:0
    ds_read_b128 v[16:19], v11 offset:18432
    ds_read_b128 v[20:23], v11 offset:36864
    ds_read_b128 v[24:27], v11 offset:55296
    ds_read_b128 v[28:31], v11 offset:2048
    ds_read_b128 v[32:35], v11 offset:20480
    ds_read_b128 v[36:39], v11 offset:38912
    ds_read_b128 v[40:43], v11 offset:57344
    s_waitcnt lgkmcnt(4)
    v_pk_add_f32 v[12:13], v[12:13], v[16:17]
    v_pk_add_f32 v[20:21], v[20:21], v[24:25]
    v_pk_add_f32 v[14:15], v[14:15], v[18:19]
    v_pk_add_f32 v[22:23], v[22:23], v[26:27]
    v_accvgpr_read_b32 v76, a120
    v_accvgpr_read_b32 v77, a121
    v_pk_add_f32 v[12:13], v[12:13], v[20:21]
    v_pk_add_f32 v[14:15], v[14:15], v[22:23]
    v_accvgpr_read_b32 v16, a128
    v_accvgpr_read_b32 v17, a129
    v_accvgpr_read_b32 v18, a130
    v_accvgpr_read_b32 v19, a131
    v_lshlrev_b32 v78, 16, v76
    v_and_b32 v79, 0xffff0000, v76
    v_lshlrev_b32 v80, 16, v77
    v_and_b32 v81, 0xffff0000, v77
    v_pk_add_f32 v[12:13], v[12:13], v[78:79]
    v_pk_add_f32 v[14:15], v[14:15], v[80:81]
    v_cvt_pk_bf16_f32 v76, v12, v13
    v_cvt_pk_bf16_f32 v77, v14, v15
    v_lshlrev_b32 v60, 16, v76
    v_and_b32 v61, 0xffff0000, v76
    v_lshlrev_b32 v62, 16, v77
    v_and_b32 v63, 0xffff0000, v77
    v_add_f32 v72, v72, v60
    v_fmac_f32 v73, v60, v60
    v_fmac_f32 v74, v60, v16
    v_add_f32 v72, v72, v61
    v_fmac_f32 v73, v61, v61
    v_fmac_f32 v74, v61, v17
    v_add_f32 v72, v72, v62
    v_fmac_f32 v73, v62, v62
    v_fmac_f32 v74, v62, v18
    v_add_f32 v72, v72, v63
    v_fmac_f32 v73, v63, v63
    v_fmac_f32 v74, v63, v19
    s_waitcnt lgkmcnt(0)
    v_pk_add_f32 v[28:29], v[28:29], v[32:33]
    v_pk_add_f32 v[36:37], v[36:37], v[40:41]
    v_pk_add_f32 v[30:31], v[30:31], v[34:35]
    v_pk_add_f32 v[38:39], v[38:39], v[42:43]
    v_accvgpr_read_b32 v76, a122
    v_accvgpr_read_b32 v77, a123
    v_pk_add_f32 v[28:29], v[28:29], v[36:37]
    v_pk_add_f32 v[30:31], v[30:31], v[38:39]
    v_accvgpr_read_b32 v32, a132
    v_accvgpr_read_b32 v33, a133
    v_accvgpr_read_b32 v34, a134
    v_accvgpr_read_b32 v35, a135
    v_lshlrev_b32 v78, 16, v76
    v_and_b32 v79, 0xffff0000, v76
    v_lshlrev_b32 v80, 16, v77
    v_and_b32 v81, 0xffff0000, v77
    v_pk_add_f32 v[28:29], v[28:29], v[78:79]
    v_pk_add_f32 v[30:31], v[30:31], v[80:81]
    v_cvt_pk_bf16_f32 v76, v28, v29
    v_cvt_pk_bf16_f32 v77, v30, v31
    v_lshlrev_b32 v64, 16, v76
    v_and_b32 v65, 0xffff0000, v76
    v_lshlrev_b32 v66, 16, v77
    v_and_b32 v67, 0xffff0000, v77
    v_add_f32 v72, v72, v64
    v_fmac_f32 v73, v64, v64
    v_fmac_f32 v74, v64, v32
    v_add_f32 v72, v72, v65
    v_fmac_f32 v73, v65, v65
    v_fmac_f32 v74, v65, v33
    v_add_f32 v72, v72, v66
    v_fmac_f32 v73, v66, v66
    v_fmac_f32 v74, v66, v34
    v_add_f32 v72, v72, v67
    v_fmac_f32 v73, v67, v67
    v_fmac_f32 v74, v67, v35
    s_cmp_lg_u32 s57, 0
    s_cbranch_scc1 NOT2_19
    ds_read_b128 v[44:47], v11 offset:4096
    ds_read_b128 v[48:51], v11 offset:22528
    ds_read_b128 v[52:55], v11 offset:40960
    ds_read_b128 v[56:59], v11 offset:59392
    s_waitcnt lgkmcnt(0)
    v_pk_add_f32 v[44:45], v[44:45], v[48:49]
    v_pk_add_f32 v[52:53], v[52:53], v[56:57]
    v_pk_add_f32 v[46:47], v[46:47], v[50:51]
    v_pk_add_f32 v[54:55], v[54:55], v[58:59]
    v_accvgpr_read_b32 v76, a124
    v_accvgpr_read_b32 v77, a125
    v_pk_add_f32 v[44:45], v[44:45], v[52:53]
    v_pk_add_f32 v[46:47], v[46:47], v[54:55]
    v_accvgpr_read_b32 v48, a136
    v_accvgpr_read_b32 v49, a137
    v_accvgpr_read_b32 v50, a138
    v_accvgpr_read_b32 v51, a139
    v_lshlrev_b32 v78, 16, v76
    v_and_b32 v79, 0xffff0000, v76
    v_lshlrev_b32 v80, 16, v77
    v_and_b32 v81, 0xffff0000, v77
    v_pk_add_f32 v[44:45], v[44:45], v[78:79]
    v_pk_add_f32 v[46:47], v[46:47], v[80:81]
    v_cvt_pk_bf16_f32 v76, v44, v45
    v_cvt_pk_bf16_f32 v77, v46, v47
    v_lshlrev_b32 v68, 16, v76
    v_and_b32 v69, 0xffff0000, v76
    v_lshlrev_b32 v70, 16, v77
    v_and_b32 v71, 0xffff0000, v77
    v_add_f32 v72, v72, v68
    v_fmac_f32 v73, v68, v68
    v_fmac_f32 v74, v68, v48
    v_add_f32 v72, v72, v69
    v_fmac_f32 v73, v69, v69
    v_fmac_f32 v74, v69, v49
    v_add_f32 v72, v72, v70
    v_fmac_f32 v73, v70, v70
    v_fmac_f32 v74, v70, v50
    v_add_f32 v72, v72, v71
    v_fmac_f32 v73, v71, v71
    v_fmac_f32 v74, v71, v51
NOT2_19:
    s_nop 1
    v_mov_b32 v76, v72
    v_mov_b32 v77, v73
    v_mov_b32 v78, v74
    v_permlane16_swap_b32 v72, v76
    v_permlane16_swap_b32 v73, v77
    v_permlane16_swap_b32 v74, v78
    v_add_f32 v72, v72, v76
    v_add_f32 v73, v73, v77
    v_add_f32 v74, v74, v78
    v_mov_b32 v76, v72
    v_mov_b32 v77, v73
    v_mov_b32 v78, v74
    v_permlane32_swap_b32 v72, v76
    v_permlane32_swap_b32 v73, v77
    v_permlane32_swap_b32 v74, v78
    v_add_f32 v72, v72, v76
    v_add_f32 v73, v73, v77
    v_add_f32 v74, v74, v78
    s_lshl_b32 s46, s56, 2
    s_add_u32 s46, s46, s57
    s_lshl_b32 s46, s46, 8
    s_add_u32 s46, s46, 152128
    v_lshlrev_b32 v8, 4, v2
    v_add_u32 v8, s46, v8
    s_mov_b64 exec, 0xffff
    ds_write_b128 v8, v[72:75]
    s_mov_b64 exec, -1
    s_waitcnt lgkmcnt(0)
    s_barrier
    s_cmp_lg_u32 s57, 0
    s_cbranch_scc1 NOPUB_20
    s_lshl_b32 s46, s56, 10
    s_add_u32 s46, s46, 152128
    v_lshlrev_b32 v8, 8, v3
    v_lshl_add_u32 v8, v2, 4, v8
    v_add_u32 v8, s46, v8
    ds_read_b128 v[76:79], v8
    s_waitcnt lgkmcnt(0)
    v_mov_b32 v80, v76
    v_mov_b32 v81, v77
    v_mov_b32 v82, v78
    v_permlane16_swap_b32 v76, v80
    v_permlane16_swap_b32 v77, v81
    v_permlane16_swap_b32 v78, v82
    v_add_f32 v76, v76, v80
    v_add_f32 v77, v77, v81
    v_add_f32 v78, v78, v82
    v_mov_b32 v80, v76
    v_mov_b32 v81, v77
    v_mov_b32 v82, v78
    v_permlane32_swap_b32 v76, v80
    v_permlane32_swap_b32 v77, v81
    v_permlane32_swap_b32 v78, v82
    v_add_f32 v76, v76, v80
    v_add_f32 v77, v77, v81
    v_add_f32 v78, v78, v82
    s_lshl_b32 s46, s42, 1
    s_add_u32 s46, s46, s56
    s_lshl_b32 s46, s46, 2
    s_add_u32 s46, s46, s43
    s_lshl_b32 s46, s46, 8
    s_add_u32 s46, s46, 9396224
    v_lshlrev_b32 v8, 4, v2
    v_add_u32 v8, s46, v8
    v_mov_b32 v79, 0
    s_mov_b64 exec, 0xffff
    buffer_store_dwordx4 v[76:79], v8, s[16:19], 0 offen sc1
    s_mov_b64 exec, -1
NOPUB_20:
    s_cmp_lt_u32 s3, 4
    s_cbranch_scc1 NOGU_21
    s_cmp_ge_u32 s61, 144
    s_cbranch_scc1 NOGU_21
    v_lshrrev_b32 v9, 2, v0
    v_mul_u32_u24 v9, 9216, v9
    v_and_b32 v10, 3, v0
    v_lshl_add_u32 v9, v10, 4, v9
    s_lshl_b32 s46, s61, 6
    v_add_u32 v9, s46, v9
    s_lshr_b32 s46, s55, 1
    s_and_b32 s47, s55, 1
    s_mul_i32 s48, s46, 36864
    s_mul_i32 s49, s47, 18432
    s_add_u32 s48, s48, s49
    s_add_u32 s48, s48, 73728
    s_mul_i32 s49, s47, 2654208
    s_cmp_eq_u32 s46, 1
    s_cbranch_scc1 GUUP_22
    s_add_u32 m0, s48, 6144
    s_add_u32 s50, s49, 884736
    buffer_load_dwordx4 v9, s[28:31], s50 offen nt lds
    s_add_u32 m0, s48, 7168
    s_add_u32 s50, s49, 1032192
    buffer_load_dwordx4 v9, s[28:31], s50 offen nt lds
    s_add_u32 m0, s48, 8192
    s_add_u32 s50, s49, 1179648
    buffer_load_dwordx4 v9, s[28:31], s50 offen nt lds
    s_add_u32 m0, s48, 9216
    s_add_u32 s50, s49, 1327104
    buffer_load_dwordx4 v9, s[28:31], s50 offen nt lds
    s_add_u32 m0, s48, 10240
    s_add_u32 s50, s49, 1474560
    buffer_load_dwordx4 v9, s[28:31], s50 offen nt lds
    s_add_u32 m0, s48, 11264
    s_add_u32 s50, s49, 1622016
    buffer_load_dwordx4 v9, s[28:31], s50 offen nt lds
    s_add_u32 m0, s48, 12288
    s_add_u32 s50, s49, 1769472
    buffer_load_dwordx4 v9, s[28:31], s50 offen nt lds
    s_add_u32 m0, s48, 13312
    s_add_u32 s50, s49, 1916928
    buffer_load_dwordx4 v9, s[28:31], s50 offen nt lds
    s_add_u32 m0, s48, 14336
    s_add_u32 s50, s49, 2064384
    buffer_load_dwordx4 v9, s[28:31], s50 offen nt lds
    s_add_u32 m0, s48, 15360
    s_add_u32 s50, s49, 2211840
    buffer_load_dwordx4 v9, s[28:31], s50 offen nt lds
    s_add_u32 m0, s48, 16384
    s_add_u32 s50, s49, 2359296
    buffer_load_dwordx4 v9, s[28:31], s50 offen nt lds
    s_add_u32 m0, s48, 17408
    s_add_u32 s50, s49, 2506752
    buffer_load_dwordx4 v9, s[28:31], s50 offen nt lds
    s_branch GUDONE_23
GUUP_22:
    s_add_u32 m0, s48, 6144
    s_add_u32 s50, s49, 884736
    buffer_load_dwordx4 v9, s[32:35], s50 offen nt lds
    s_add_u32 m0, s48, 7168
    s_add_u32 s50, s49, 1032192
    buffer_load_dwordx4 v9, s[32:35], s50 offen nt lds
    s_add_u32 m0, s48, 8192
    s_add_u32 s50, s49, 1179648
    buffer_load_dwordx4 v9, s[32:35], s50 offen nt lds
    s_add_u32 m0, s48, 9216
    s_add_u32 s50, s49, 1327104
    buffer_load_dwordx4 v9, s[32:35], s50 offen nt lds
    s_add_u32 m0, s48, 10240
    s_add_u32 s50, s49, 1474560
    buffer_load_dwordx4 v9, s[32:35], s50 offen nt lds
    s_add_u32 m0, s48, 11264
    s_add_u32 s50, s49, 1622016
    buffer_load_dwordx4 v9, s[32:35], s50 offen nt lds
    s_add_u32 m0, s48, 12288
    s_add_u32 s50, s49, 1769472
    buffer_load_dwordx4 v9, s[32:35], s50 offen nt lds
    s_add_u32 m0, s48, 13312
    s_add_u32 s50, s49, 1916928
    buffer_load_dwordx4 v9, s[32:35], s50 offen nt lds
    s_add_u32 m0, s48, 14336
    s_add_u32 s50, s49, 2064384
    buffer_load_dwordx4 v9, s[32:35], s50 offen nt lds
    s_add_u32 m0, s48, 15360
    s_add_u32 s50, s49, 2211840
    buffer_load_dwordx4 v9, s[32:35], s50 offen nt lds
    s_add_u32 m0, s48, 16384
    s_add_u32 s50, s49, 2359296
    buffer_load_dwordx4 v9, s[32:35], s50 offen nt lds
    s_add_u32 m0, s48, 17408
    s_add_u32 s50, s49, 2506752
    buffer_load_dwordx4 v9, s[32:35], s50 offen nt lds
GUDONE_23:
NOGU_21:
    s_cmp_lt_u32 s3, 4
    s_cbranch_scc1 NODN_24
    s_cmp_ge_u32 s61, 144
    s_cbranch_scc1 NODN_24
    s_mul_i32 s46, s61, 36864
    s_mul_i32 s47, s55, 9216
    s_add_u32 s46, s46, s47
    v_add_u32 v9, s46, v1
    s_add_u32 m0, s47, 0
    s_mov_b32 s48, 0
    buffer_load_dwordx4 v9, s[36:39], s48 offen offset:0 nt lds
    buffer_load_dwordx4 v9, s[36:39], s48 offen offset:1024 nt lds
    buffer_load_dwordx4 v9, s[36:39], s48 offen offset:2048 nt lds
    buffer_load_dwordx4 v9, s[36:39], s48 offen offset:3072 nt lds
    s_add_u32 m0, s47, 4096
    s_mov_b32 s48, 4096
    buffer_load_dwordx4 v9, s[36:39], s48 offen offset:0 nt lds
    buffer_load_dwordx4 v9, s[36:39], s48 offen offset:1024 nt lds
    buffer_load_dwordx4 v9, s[36:39], s48 offen offset:2048 nt lds
    buffer_load_dwordx4 v9, s[36:39], s48 offen offset:3072 nt lds
    s_add_u32 m0, s47, 8192
    s_mov_b32 s48, 8192
    buffer_load_dwordx4 v9, s[36:39], s48 offen offset:0 nt lds
NODN_24:
    s_cmp_lg_u32 s57, 0
    s_cbranch_scc1 NOH3_25
    s_lshl_b32 s46, s42, 1
    s_add_u32 s46, s46, s56
    s_lshl_b32 s46, s46, 10
    s_add_u32 s46, s46, 9396224
    v_lshlrev_b32 v8, 8, v3
    v_lshl_add_u32 v8, v2, 4, v8
    v_add_u32 v8, s46, v8
    s_mov_b32 s62, 3000
POLL_26:
    buffer_load_dwordx4 v[76:79], v8, s[16:19], 0 offen sc1
    s_waitcnt vmcnt(0)
    v_add_f32 v80, v76, v77
    v_add_f32 v80, v80, v78
    v_cmp_u_f32 vcc, v80, v80
    s_cbranch_vccz PDONE_27
    s_sub_u32 s62, s62, 1
    s_cbranch_scc1 PDONE_27
    s_sleep 1
    s_branch POLL_26
PDONE_27:
    v_mov_b32 v80, v76
    v_mov_b32 v81, v77
    v_mov_b32 v82, v78
    v_permlane16_swap_b32 v76, v80
    v_permlane16_swap_b32 v77, v81
    v_permlane16_swap_b32 v78, v82
    v_add_f32 v76, v76, v80
    v_add_f32 v77, v77, v81
    v_add_f32 v78, v78, v82
    v_mov_b32 v80, v76
    v_mov_b32 v81, v77
    v_mov_b32 v82, v78
    v_permlane32_swap_b32 v76, v80
    v_permlane32_swap_b32 v77, v81
    v_permlane32_swap_b32 v78, v82
    v_add_f32 v76, v76, v80
    v_add_f32 v77, v77, v81
    v_add_f32 v78, v78, v82
    s_mov_b32 s46, 0x3AE38E39
    v_mul_f32 v72, s46, v76
    v_mul_f32 v77, s46, v77
    v_fma_f32 v77, -v72, v72, v77
    v_add_f32 v77, 0x3727c5ac, v77
    v_rsq_f32 v73, v77
    s_nop 0
    v_mul_f32 v74, v78, v73
    v_ashrrev_i32 v76, 31, v74
    v_or_b32 v76, 0x80000000, v76
    v_xor_b32 v76, v76, v74
    s_mov_b32 s46, 0xfffff800
    v_and_or_b32 v75, v76, s46, v5
    v_lshlrev_b32 v8, 2, v5
    v_add_u32 v8, 9527296, v8
    v_mov_b32 v9, 1073741824
    s_cmp_eq_u32 s43, 0
    s_cselect_b64 vcc, -1, 0
    v_cndmask_b32 v8, v9, v8, vcc
    s_lshl_b32 s46, s56, 8
    s_add_u32 s46, s46, 162048
    v_lshlrev_b32 v9, 4, v2
    v_add_u32 v9, s46, v9
    s_mov_b64 exec, 0xffff
    buffer_store_dword v75, v8, s[16:19], 0 offen sc1
    ds_write_b128 v9, v[72:75]
    s_mov_b64 exec, -1
    s_lshl_b32 s46, s56, 2
    s_add_u32 s46, s46, 154208
    v_mov_b32 v9, s46
    v_mov_b32 v8, 1
    ds_write_b32 v9, v8
    s_waitcnt lgkmcnt(0)
NOH3_25:
    v_lshlrev_b32 v8, 4, v4
    v_add_u32 v8, 9527296, v8
    s_lshl_b32 s46, s42, 7
    s_add_u32 s46, s46, 9527296
    v_lshlrev_b32 v9, 2, v0
    v_add_u32 v9, s46, v9
    v_mov_b32 v10, 1073741824
    v_cmp_gt_u32 vcc, 32, v0
    s_nop 1
    v_cndmask_b32 v9, v10, v9, vcc
    s_mov_b32 s62, 3000
POLL_28:
    buffer_load_dwordx4 v[80:83], v8, s[16:19], 0 offen sc1
    buffer_load_dword v84, v9, s[16:19], 0 offen sc1
    s_waitcnt vmcnt(0)
    v_max3_u32 v85, v80, v81, v82
    v_max_u32 v85, v85, v83
    v_max_u32 v86, v85, v84
    v_cmp_eq_u32 vcc, -1, v86
    s_cbranch_vccz PDONE_29
    s_sub_u32 s62, s62, 1
    s_cbranch_scc1 PDONE_29
    s_sleep 1
    s_branch POLL_28
PDONE_29:
    v_max_u32_dpp v85, v85, v85 quad_perm:[1,0,3,2] row_mask:0xf bank_mask:0xf
    s_nop 1
    v_max_u32_dpp v85, v85, v85 quad_perm:[2,3,0,1] row_mask:0xf bank_mask:0xf
    s_nop 1
    v_max_u32_dpp v85, v85, v85 row_half_mirror row_mask:0xf bank_mask:0xf
    s_nop 1
    v_max_u32_dpp v85, v85, v85 row_mirror row_mask:0xf bank_mask:0xf
    v_mov_b32 v86, v85
    s_nop 1
    v_permlane16_swap_b32 v85, v86
    v_max_u32 v85, v85, v86
    v_mov_b32 v86, v85
    s_nop 1
    v_permlane32_swap_b32 v85, v86
    v_max_u32 v85, v85, v86
    s_lshl_b32 s46, s3, 2
    s_add_u32 s46, s46, 154176
    v_mov_b32 v86, s46
    s_mov_b64 exec, 1
    ds_write_b32 v86, v85
    s_mov_b64 exec, -1
    s_waitcnt lgkmcnt(0)
    s_barrier
    v_mov_b32 v86, 154176
    ds_read_b128 v[88:91], v86
    ds_read_b128 v[92:95], v86 offset:16
    s_waitcnt lgkmcnt(0)
    v_min3_u32 v88, v88, v89, v90
    v_min3_u32 v91, v91, v92, v93
    v_min3_u32 v88, v88, v94, v95
    v_min_u32 v88, v88, v91
    s_lshl_b32 s46, s56, 8
    s_add_u32 s46, s46, 162048
    v_lshlrev_b32 v86, 4, v2
    v_add_u32 v86, s46, v86
    ds_read_b128 v[72:75], v86
    v_cmp_ge_u32 vcc, v84, v88
    s_mov_b64 s[50:51], vcc
CAND_30:
    s_cmp_eq_u32 s50, 0
    s_cbranch_scc1 CANDD_31
    s_ff1_i32_b32 s46, s50
    s_bitset0_b32 s50, s46
    v_readlane_b32 s47, v84, s46
    s_nop 3
    s_mov_b32 s48, 0
    v_cmp_lt_u32 vcc, s47, v80
    s_bcnt1_i32_b64 s49, vcc
    s_add_u32 s48, s48, s49
    v_cmp_lt_u32 vcc, s47, v81
    s_bcnt1_i32_b64 s49, vcc
    s_add_u32 s48, s48, s49
    v_cmp_lt_u32 vcc, s47, v82
    s_bcnt1_i32_b64 s49, vcc
    s_add_u32 s48, s48, s49
    v_cmp_lt_u32 vcc, s47, v83
    s_bcnt1_i32_b64 s49, vcc
    s_add_u32 s48, s48, s49
    s_lshl_b32 s46, s46, 2
    s_add_u32 s46, s46, 154240
    v_mov_b32 v86, s46
    v_mov_b32 v87, s48
    s_mov_b64 exec, 1
    ds_add_u32 v86, v87
    s_mov_b64 exec, -1
    s_branch CAND_30
CANDD_31:
    s_waitcnt lgkmcnt(0)
    v_mul_f32 v76, v72, v73
    v_sub_f32 v76, 0, v76
    v_mov_b32 v77, v76
    v_mov_b32 v78, v73
    v_mov_b32 v79, v73
    v_pk_fma_f32 v[12:13], v[60:61], v[78:79], v[76:77]
    v_pk_fma_f32 v[14:15], v[62:63], v[78:79], v[76:77]
    v_pk_fma_f32 v[16:17], v[64:65], v[78:79], v[76:77]
    v_pk_fma_f32 v[18:19], v[66:67], v[78:79], v[76:77]
    v_pk_fma_f32 v[20:21], v[68:69], v[78:79], v[76:77]
    v_pk_fma_f32 v[22:23], v[70:71], v[78:79], v[76:77]
    s_waitcnt lgkmcnt(0)
    s_barrier
    s_lshl_b32 s46, s56, 6
    s_add_u32 s46, s46, 154240
    v_lshlrev_b32 v86, 2, v2
    v_add_u32 v86, s46, v86
    ds_read_b32 v87, v86
    s_waitcnt lgkmcnt(0)
    v_cmp_ge_u32 s[50:51], v75, v88
    v_cmp_gt_u32 vcc, 8, v87
    s_and_b64 s[50:51], s[50:51], vcc
    v_pk_add_f32 v[24:25], v[60:61], v[12:13]
    v_pk_add_f32 v[26:27], v[62:63], v[14:15]
    v_pk_add_f32 v[28:29], v[64:65], v[16:17]
    v_pk_add_f32 v[30:31], v[66:67], v[18:19]
    v_pk_add_f32 v[32:33], v[68:69], v[20:21]
    v_pk_add_f32 v[34:35], v[70:71], v[22:23]
    v_cvt_pk_bf16_f32 v36, v24, v25
    v_cvt_pk_bf16_f32 v37, v26, v27
    v_cvt_pk_bf16_f32 v38, v28, v29
    v_cvt_pk_bf16_f32 v39, v30, v31
    v_cvt_pk_bf16_f32 v40, v32, v33
    v_cvt_pk_bf16_f32 v41, v34, v35
    v_cvt_pk_bf16_f32 v42, v12, v13
    v_cvt_pk_bf16_f32 v43, v14, v15
    v_cvt_pk_bf16_f32 v44, v16, v17
    v_cvt_pk_bf16_f32 v45, v18, v19
    v_cvt_pk_bf16_f32 v46, v20, v21
    v_cvt_pk_bf16_f32 v47, v22, v23
    v_mul_u32_u24 v8, 1152, v87
    v_lshl_add_u32 v8, v7, 1, v8
    v_add_u32 v8, 9535488, v8
    v_mul_u32_u24 v9, 2304, v87
    v_lshl_add_u32 v9, v7, 2, v9
    v_add_u32 v9, 9544704, v9
    v_lshlrev_b32 v10, 3, v87
    v_add_u32 v10, 9563136, v10
    v_mov_b32 v48, v5
    v_mov_b32 v49, v74
    s_cmp_eq_u32 s57, 0
    s_cbranch_scc1 ST3_32
    s_and_saveexec_b64 s[52:53], s[50:51]
    s_cbranch_execz NOSEL_34
    buffer_store_dwordx2 v[42:43], v8, s[16:19], 0 offen offset:0 sc1
    buffer_store_dwordx4 v[24:27], v9, s[16:19], 0 offen offset:0 sc1
    buffer_store_dwordx2 v[44:45], v8, s[16:19], 0 offen offset:32 sc1
    buffer_store_dwordx4 v[28:31], v9, s[16:19], 0 offen offset:64 sc1
NOSEL_34:
    s_mov_b64 exec, s[52:53]
    s_branch STJ_33
ST3_32:
    s_and_saveexec_b64 s[52:53], s[50:51]
    s_cbranch_execz NOSEL_35
    buffer_store_dwordx2 v[42:43], v8, s[16:19], 0 offen offset:0 sc1
    buffer_store_dwordx4 v[24:27], v9, s[16:19], 0 offen offset:0 sc1
    buffer_store_dwordx2 v[44:45], v8, s[16:19], 0 offen offset:32 sc1
    buffer_store_dwordx4 v[28:31], v9, s[16:19], 0 offen offset:64 sc1
    buffer_store_dwordx2 v[46:47], v8, s[16:19], 0 offen offset:64 sc1
    buffer_store_dwordx4 v[32:35], v9, s[16:19], 0 offen offset:128 sc1
NOSEL_35:
    s_mov_b64 exec, s[52:53]
    s_cmp_lg_u32 s43, 0
    s_cbranch_scc1 NOMETA_36
    s_and_b64 s[52:53], s[50:51], 0xffff
    s_and_saveexec_b64 s[48:49], s[52:53]
    s_cbranch_execz NOMETA_36_R
    buffer_store_dwordx2 v[48:49], v10, s[16:19], 0 offen sc1
NOMETA_36_R:
    s_mov_b64 exec, -1
NOMETA_36:
STJ_33:
    s_mov_b64 exec, -1
    s_barrier
    s_cmp_eq_u32 s57, 0
    s_cbranch_scc1 OUT3_37
    s_andn2_b64 exec, exec, s[50:51]
    s_cbranch_execz NOOUT_39
    buffer_store_dwordx2 v[36:37], v6, s[24:27], 0 offen offset:0
    buffer_store_dwordx2 v[38:39], v6, s[24:27], 0 offen offset:32
NOOUT_39:
    s_mov_b64 exec, -1
    s_branch OUTJ_38
OUT3_37:
    s_andn2_b64 exec, exec, s[50:51]
    s_cbranch_execz NOOUT_40
    buffer_store_dwordx2 v[36:37], v6, s[24:27], 0 offen offset:0
    buffer_store_dwordx2 v[38:39], v6, s[24:27], 0 offen offset:32
    buffer_store_dwordx2 v[40:41], v6, s[24:27], 0 offen offset:64
NOOUT_40:
    s_mov_b64 exec, -1
OUTJ_38:
    s_cmp_ge_u32 s61, 144
    s_cbranch_scc1 FINAL_41
    s_mul_i32 s46, s3, 3
    s_lshl_b32 s47, s3, 1
    s_add_u32 s47, s47, 2
    s_cmp_lt_u32 s3, 2
    s_cselect_b32 s46, s46, s47
    v_and_b32 v26, 7, v2
    v_mul_u32_u24 v8, 1152, v26
    v_lshl_add_u32 v8, v3, 4, v8
    s_lshl_b32 s47, s46, 6
    s_add_u32 s47, s47, 9535488
    v_add_u32 v8, s47, v8
    v_lshrrev_b32 v24, 2, v2
    v_lshl_add_u32 v24, v3, 3, v24
    v_and_b32 v25, 3, v2
    v_lshlrev_b32 v25, 3, v25
    v_lshl_add_u32 v9, v24, 6, v25
    s_lshl_b32 s47, s46, 11
    s_add_u32 s47, s47, 73728
    v_add_u32 v9, s47, v9
    v_add_u32 v10, 36864, v9
    ds_read_b64_tr_b16 v[28:29], v9 offset:0
    ds_read_b64_tr_b16 v[30:31], v9 offset:256
    ds_read_b64_tr_b16 v[32:33], v9 offset:32
    ds_read_b64_tr_b16 v[34:35], v9 offset:288
    ds_read_b64_tr_b16 v[36:37], v10 offset:0
    ds_read_b64_tr_b16 v[38:39], v10 offset:256
    ds_read_b64_tr_b16 v[40:41], v10 offset:32
    ds_read_b64_tr_b16 v[42:43], v10 offset:288
    v_mul_u32_u24 v11, 1152, v24
    v_add_u32 v11, v11, v25
    s_lshl_b32 s47, s3, 7
    s_add_u32 s47, s47, 0
    v_add_u32 v11, s47, v11
    s_waitcnt lgkmcnt(0)
    ds_read_b64_tr_b16 v[44:45], v9 offset:2048
    ds_read_b64_tr_b16 v[46:47], v9 offset:2304
    ds_read_b64_tr_b16 v[48:49], v9 offset:2080
    ds_read_b64_tr_b16 v[50:51], v9 offset:2336
    ds_read_b64_tr_b16 v[52:53], v10 offset:2048
    ds_read_b64_tr_b16 v[54:55], v10 offset:2304
    ds_read_b64_tr_b16 v[56:57], v10 offset:2080
    ds_read_b64_tr_b16 v[58:59], v10 offset:2336
    v_lshlrev_b32 v26, 6, v26
    v_lshl_add_u32 v26, v3, 4, v26
    v_add_u32 v26, 154368, v26
    v_and_b32 v27, 7, v2
    v_mul_u32_u24 v27, 165888, v27
    v_lshrrev_b32 v92, 3, v2
    v_lshl_add_u32 v27, v92, 6, v27
    v_and_b32 v92, 1, v3
    v_lshl_add_u32 v27, v92, 5, v27
    v_lshrrev_b32 v92, 1, v3
    v_lshl_add_u32 v27, v92, 4, v27
    s_lshl_b32 s47, s61, 7
    s_add_u32 s47, s47, 9563392
    v_add_u32 v27, s47, v27
    s_mul_i32 s49, s3, 18432
    s_waitcnt lgkmcnt(0)
    ds_read_b64_tr_b16 v[60:61], v9 offset:4096
    ds_read_b64_tr_b16 v[62:63], v9 offset:4352
    ds_read_b64_tr_b16 v[64:65], v9 offset:4128
    ds_read_b64_tr_b16 v[66:67], v9 offset:4384
    ds_read_b64_tr_b16 v[68:69], v10 offset:4096
    ds_read_b64_tr_b16 v[70:71], v10 offset:4352
    ds_read_b64_tr_b16 v[72:73], v10 offset:4128
    ds_read_b64_tr_b16 v[74:75], v10 offset:4384
    s_waitcnt lgkmcnt(0)
    ds_read_b64_tr_b16 v[76:77], v11 offset:0
    ds_read_b64_tr_b16 v[78:79], v11 offset:4608
    ds_read_b64_tr_b16 v[80:81], v11 offset:32
    ds_read_b64_tr_b16 v[82:83], v11 offset:4640
    ds_read_b64_tr_b16 v[84:85], v11 offset:64
    ds_read_b64_tr_b16 v[86:87], v11 offset:4672
    ds_read_b64_tr_b16 v[88:89], v11 offset:96
    ds_read_b64_tr_b16 v[90:91], v11 offset:4704
    v_mov_b32 v93, v11
    v_and_b32 v24, 31, v4
    v_lshrrev_b32 v25, 5, v4
    v_lshrrev_b32 v9, 4, v24
    v_lshlrev_b32 v9, 10, v9
    v_bfe_u32 v10, v24, 2, 2
    v_and_b32 v11, 7, v25
    v_lshl_add_u32 v10, v10, 4, v11
    v_lshl_add_u32 v9, v10, 4, v9
    v_and_b32 v10, 3, v24
    v_lshl_add_u32 v9, v10, 2, v9
    v_add_u32 v9, 36864, v9
    v_lshlrev_b32 v10, 6, v11
    v_lshl_add_u32 v10, v24, 1, v10
    v_add_u32 v10, 154368, v10
    s_lshl_b32 s47, s3, 12
    s_add_u32 s47, s47, 36864
    v_add_u32 v11, s47, v1
    s_cmp_lt_u32 s3, 2
    s_cselect_b32 s47, -1, 0
    s_waitcnt lgkmcnt(0)
    s_mov_b32 s62, 3000
POLL_42:
    buffer_load_dwordx4 v[12:15], v8, s[16:19], 0 offen offset:0 sc1
    buffer_load_dwordx4 v[16:19], v8, s[16:19], 0 offen offset:64 sc1
    buffer_load_dwordx4 v[20:23], v8, s[16:19], 0 offen offset:128 sc1
    s_waitcnt vmcnt(0)
    v_max3_u32 v24, v12, v13, v14
    v_max3_u32 v24, v24, v15, v16
    v_max3_u32 v24, v24, v17, v18
    v_max3_u32 v25, v20, v21, v22
    v_max_u32 v25, v25, v23
    v_and_b32 v25, s47, v25
    v_max3_u32 v24, v24, v25, v19
    v_cmp_eq_u32 vcc, -1, v24
    s_cbranch_vccz PDONE_43
    s_sub_u32 s62, s62, 1
    s_cbranch_scc1 PDONE_43
    s_sleep 1
    s_branch POLL_42
PDONE_43:
    v_mfma_f32_16x16x32_bf16 v[96:99], v[28:31], v[12:15], 0
    v_mfma_f32_16x16x32_bf16 v[100:103], v[32:35], v[12:15], 0
    v_mfma_f32_16x16x32_bf16 v[104:107], v[36:39], v[12:15], 0
    v_mfma_f32_16x16x32_bf16 v[108:111], v[40:43], v[12:15], 0
    v_mfma_f32_16x16x32_bf16 v[96:99], v[44:47], v[16:19], v[96:99]
    v_mfma_f32_16x16x32_bf16 v[100:103], v[48:51], v[16:19], v[100:103]
    v_mfma_f32_16x16x32_bf16 v[104:107], v[52:55], v[16:19], v[104:107]
    v_mfma_f32_16x16x32_bf16 v[108:111], v[56:59], v[16:19], v[108:111]
    s_cmp_ge_u32 s3, 2
    s_cbranch_scc1 GU2_44
    v_mfma_f32_16x16x32_bf16 v[96:99], v[60:63], v[20:23], v[96:99]
    v_mfma_f32_16x16x32_bf16 v[100:103], v[64:67], v[20:23], v[100:103]
    v_mfma_f32_16x16x32_bf16 v[104:107], v[68:71], v[20:23], v[104:107]
    v_mfma_f32_16x16x32_bf16 v[108:111], v[72:75], v[20:23], v[108:111]
GU2_44:
    s_nop 7
    ds_write_b128 v11, v[96:99] offset:0
    ds_write_b128 v11, v[100:103] offset:1024
    ds_write_b128 v11, v[104:107] offset:2048
    ds_write_b128 v11, v[108:111] offset:3072
    s_waitcnt lgkmcnt(0)
    s_barrier
    s_cmp_ge_u32 s3, 4
    s_cbranch_scc1 ASKIP_45
    ds_read_b32 v28, v9 offset:0
    ds_read_b32 v29, v9 offset:4096
    ds_read_b32 v30, v9 offset:8192
    ds_read_b32 v31, v9 offset:12288
    ds_read_b32 v32, v9 offset:16384
    ds_read_b32 v33, v9 offset:20480
    ds_read_b32 v34, v9 offset:24576
    ds_read_b32 v35, v9 offset:28672
    ds_read_b32 v36, v9 offset:2048
    ds_read_b32 v37, v9 offset:6144
    ds_read_b32 v38, v9 offset:10240
    ds_read_b32 v39, v9 offset:14336
    ds_read_b32 v40, v9 offset:18432
    ds_read_b32 v41, v9 offset:22528
    ds_read_b32 v42, v9 offset:26624
    s_waitcnt lgkmcnt(7)
    ds_read_b32 v43, v9 offset:30720
    v_add_f32 v28, v28, v29
    v_add_f32 v30, v30, v31
    v_add_f32 v32, v32, v33
    v_add_f32 v34, v34, v35
    v_add_f32 v28, v28, v30
    v_add_f32 v32, v32, v34
    v_add_f32 v28, v28, v32
    v_mul_f32 v29, 0xbfb8aa3b, v28
    v_exp_f32 v29, v29
    s_nop 0
    v_add_f32 v29, 1.0, v29
    v_rcp_f32 v29, v29
    s_waitcnt lgkmcnt(0)
    v_add_f32 v36, v36, v37
    v_add_f32 v38, v38, v39
    v_add_f32 v40, v40, v41
    v_add_f32 v42, v42, v43
    v_add_f32 v36, v36, v38
    v_add_f32 v40, v40, v42
    v_mul_f32 v28, v28, v29
    v_add_f32 v36, v36, v40
    v_mul_f32 v28, v28, v36
    v_cvt_pk_bf16_f32 v28, v28, v28
    ds_write_b16 v10, v28
    s_waitcnt lgkmcnt(0)
ASKIP_45:
    s_barrier
    ds_read_b128 v[12:15], v26
    s_waitcnt lgkmcnt(0)
    v_mfma_f32_16x16x32_bf16 v[28:31], v[76:79], v[12:15], 0
    v_mfma_f32_16x16x32_bf16 v[32:35], v[80:83], v[12:15], 0
    v_mfma_f32_16x16x32_bf16 v[36:39], v[84:87], v[12:15], 0
    v_mfma_f32_16x16x32_bf16 v[40:43], v[88:91], v[12:15], 0
    s_nop 4
    v_cvt_pk_bf16_f32 v44, v28, v29
    v_cvt_pk_bf16_f32 v45, v30, v31
    v_cvt_pk_bf16_f32 v46, v32, v33
    v_cvt_pk_bf16_f32 v47, v34, v35
    v_cvt_pk_bf16_f32 v48, v36, v37
    v_cvt_pk_bf16_f32 v49, v38, v39
    v_cvt_pk_bf16_f32 v50, v40, v41
    v_cvt_pk_bf16_f32 v51, v42, v43
    v_permlane16_swap_b32 v44, v46
    v_permlane16_swap_b32 v45, v47
    v_permlane16_swap_b32 v48, v50
    v_permlane16_swap_b32 v49, v51
    v_cmp_lt_u32 vcc, 7, v2
    s_nop 1
    v_cndmask_b32 v52, v44, v48, vcc
    v_cndmask_b32 v53, v45, v49, vcc
    v_cndmask_b32 v54, v46, v50, vcc
    v_cndmask_b32 v55, v47, v51, vcc
    buffer_store_dwordx4 v[52:55], v27, s[16:19], s49 offen sc1
    s_cmp_lg_u32 s3, 4
    s_cbranch_scc1 DNJ_46
    ds_read_b64_tr_b16 v[76:77], v93 offset:512
    ds_read_b64_tr_b16 v[78:79], v93 offset:5120
    ds_read_b64_tr_b16 v[80:81], v93 offset:544
    ds_read_b64_tr_b16 v[82:83], v93 offset:5152
    ds_read_b64_tr_b16 v[84:85], v93 offset:576
    ds_read_b64_tr_b16 v[86:87], v93 offset:5184
    ds_read_b64_tr_b16 v[88:89], v93 offset:608
    ds_read_b64_tr_b16 v[90:91], v93 offset:5216
    s_waitcnt lgkmcnt(0)
    s_mov_b32 s49, 147456
    v_mfma_f32_16x16x32_bf16 v[28:31], v[76:79], v[12:15], 0
    v_mfma_f32_16x16x32_bf16 v[32:35], v[80:83], v[12:15], 0
    v_mfma_f32_16x16x32_bf16 v[36:39], v[84:87], v[12:15], 0
    v_mfma_f32_16x16x32_bf16 v[40:43], v[88:91], v[12:15], 0
    s_nop 4
    v_cvt_pk_bf16_f32 v44, v28, v29
    v_cvt_pk_bf16_f32 v45, v30, v31
    v_cvt_pk_bf16_f32 v46, v32, v33
    v_cvt_pk_bf16_f32 v47, v34, v35
    v_cvt_pk_bf16_f32 v48, v36, v37
    v_cvt_pk_bf16_f32 v49, v38, v39
    v_cvt_pk_bf16_f32 v50, v40, v41
    v_cvt_pk_bf16_f32 v51, v42, v43
    v_permlane16_swap_b32 v44, v46
    v_permlane16_swap_b32 v45, v47
    v_permlane16_swap_b32 v48, v50
    v_permlane16_swap_b32 v49, v51
    v_cmp_lt_u32 vcc, 7, v2
    s_nop 1
    v_cndmask_b32 v52, v44, v48, vcc
    v_cndmask_b32 v53, v45, v49, vcc
    v_cndmask_b32 v54, v46, v50, vcc
    v_cndmask_b32 v55, v47, v51, vcc
    buffer_store_dwordx4 v[52:55], v27, s[16:19], s49 offen sc1
DNJ_46:
    s_barrier
FINAL_41:
    s_cmp_ge_u32 s54, 144
    s_cbranch_scc1 K1_FIN
    s_mov_b32 s46, s54
    s_mul_hi_u32 s47, s46, 0xe38e38f
    s_mul_i32 s48, s47, 18
    s_sub_u32 s48, s46, s48
    v_and_b32 v8, 15, v4
    v_lshrrev_b32 v9, 4, v4
    s_mul_i32 s49, s47, 9
    s_lshr_b32 s50, s48, 1
    s_add_u32 s49, s49, s50
    s_mul_i32 s49, s49, 18432
    s_and_b32 s50, s48, 1
    s_lshl_b32 s50, s50, 6
    s_add_u32 s49, s49, s50
    s_add_u32 s49, s49, 9563392
    v_lshlrev_b32 v10, 7, v9
    v_lshl_add_u32 v10, v8, 2, v10
    v_add_u32 v10, s49, v10
    v_add_u32 v11, 16384, v10
    v_mov_b32 v12, 1073741824
    v_cmp_gt_u32 vcc, 16, v9
    s_nop 1
    v_cndmask_b32 v11, v12, v11, vcc
    s_mul_i32 s49, s47, 2304
    s_lshl_b32 s50, s48, 7
    s_add_u32 s49, s49, s50
    s_add_u32 s49, s49, 9544704
    v_lshlrev_b32 v13, 3, v8
    v_add_u32 v13, s49, v13
    s_lshl_b32 s49, s47, 3
    s_add_u32 s49, s49, 9563136
    v_mov_b32 v14, s49
    s_mov_b32 s62, 3000
POLL_47:
    s_mov_b32 s49, 0
    buffer_load_dword v16, v10, s[16:19], s49 offen sc1
    s_mov_b32 s50, 4096
    buffer_load_dword v17, v10, s[16:19], s50 offen sc1
    s_mov_b32 s49, 8192
    buffer_load_dword v18, v10, s[16:19], s49 offen sc1
    s_mov_b32 s50, 12288
    buffer_load_dword v19, v10, s[16:19], s50 offen sc1
    buffer_load_dword v20, v11, s[16:19], 0 offen sc1
    buffer_load_dwordx2 v[22:23], v13, s[16:19], 0 offen sc1
    buffer_load_dwordx2 v[24:25], v14, s[16:19], 0 offen sc1
    s_waitcnt vmcnt(0)
    v_max3_u32 v15, v16, v17, v18
    v_max3_u32 v15, v15, v19, v20
    v_max3_u32 v15, v15, v22, v23
    v_max_u32 v15, v15, v24
    v_cmp_eq_u32 vcc, -1, v15
    s_cbranch_vccz PDONE_48
    s_sub_u32 s62, s62, 1
    s_cbranch_scc1 PDONE_48
    s_sleep 1
    s_branch POLL_47
PDONE_48:
    v_mov_b32 v26, 0
    v_mov_b32 v27, 0
    v_lshlrev_b32 v28, 16, v16
    v_and_b32 v29, 0xffff0000, v16
    v_pk_add_f32 v[26:27], v[26:27], v[28:29]
    v_lshlrev_b32 v28, 16, v17
    v_and_b32 v29, 0xffff0000, v17
    v_pk_add_f32 v[26:27], v[26:27], v[28:29]
    v_lshlrev_b32 v28, 16, v18
    v_and_b32 v29, 0xffff0000, v18
    v_pk_add_f32 v[26:27], v[26:27], v[28:29]
    v_lshlrev_b32 v28, 16, v19
    v_and_b32 v29, 0xffff0000, v19
    v_pk_add_f32 v[26:27], v[26:27], v[28:29]
    v_lshlrev_b32 v28, 16, v20
    v_and_b32 v29, 0xffff0000, v20
    v_pk_add_f32 v[26:27], v[26:27], v[28:29]
    v_mov_b32 v28, v26
    v_mov_b32 v29, v27
    s_nop 0
    v_permlane16_swap_b32 v26, v28
    v_permlane16_swap_b32 v27, v29
    v_add_f32 v26, v26, v28
    v_add_f32 v27, v27, v29
    v_mov_b32 v28, v26
    v_mov_b32 v29, v27
    s_nop 0
    v_permlane32_swap_b32 v26, v28
    v_permlane32_swap_b32 v27, v29
    v_add_f32 v26, v26, v28
    v_add_f32 v27, v27, v29
    s_lshl_b32 s49, s3, 7
    s_add_u32 s49, s49, 154880
    v_lshlrev_b32 v28, 3, v8
    v_add_u32 v28, s49, v28
    s_mov_b64 exec, 0xffff
    ds_write_b64 v28, v[26:27]
    s_mov_b64 exec, -1
    s_waitcnt lgkmcnt(0)
    s_barrier
    s_cmp_lg_u32 s3, 0
    s_cbranch_scc1 K1_FIN
    v_lshlrev_b32 v28, 3, v8
    v_add_u32 v28, 154880, v28
    ds_read_b64 v[32:33], v28 offset:0
    ds_read_b64 v[34:35], v28 offset:128
    ds_read_b64 v[36:37], v28 offset:256
    ds_read_b64 v[38:39], v28 offset:384
    ds_read_b64 v[40:41], v28 offset:512
    ds_read_b64 v[42:43], v28 offset:640
    ds_read_b64 v[44:45], v28 offset:768
    ds_read_b64 v[46:47], v28 offset:896
    s_waitcnt lgkmcnt(0)
    v_pk_add_f32 v[32:33], v[32:33], v[34:35]
    v_pk_add_f32 v[36:37], v[36:37], v[38:39]
    v_pk_add_f32 v[40:41], v[40:41], v[42:43]
    v_pk_add_f32 v[44:45], v[44:45], v[46:47]
    v_pk_add_f32 v[32:33], v[32:33], v[36:37]
    v_pk_add_f32 v[40:41], v[40:41], v[44:45]
    v_pk_add_f32 v[32:33], v[32:33], v[40:41]
    v_mul_f32 v26, 0xbfb8aa3b, v25
    v_exp_f32 v26, v26
    s_nop 0
    v_add_f32 v26, 1.0, v26
    v_rcp_f32 v26, v26
    s_nop 0
    v_fma_f32 v22, v32, v26, v22
    v_fma_f32 v23, v33, v26, v23
    v_cvt_pk_bf16_f32 v22, v22, v23
    v_mul_u32_u24 v28, 1152, v24
    v_lshl_add_u32 v28, v8, 2, v28
    s_lshl_b32 s49, s48, 6
    v_add_u32 v28, s49, v28
    s_mov_b64 exec, 0xffff
    buffer_store_dword v22, v28, s[24:27], 0 offen
    s_mov_b64 exec, -1
K1_FIN:
K1_END:
    s_endpgm
.section .rodata,"a"
.p2align 6
.amdhsa_kernel sequential_preLN__linear_kernel_hedgehog__moe_arch_mod__prompt_kernel
  .amdhsa_next_free_vgpr 256
  .amdhsa_next_free_sgpr 102
  .amdhsa_accum_offset 112
  .amdhsa_group_segment_fixed_size 0
  .amdhsa_kernarg_size 96
  .amdhsa_user_sgpr_count 2
  .amdhsa_user_sgpr_kernarg_segment_ptr 1
  .amdhsa_system_sgpr_workgroup_id_x 1
  .amdhsa_float_denorm_mode_32 3
  .amdhsa_float_denorm_mode_16_64 3
.end_amdhsa_kernel
```
